```python
import torch

def _softmax(x, axis=-1):
    return torch.softmax(x, dim=axis)

def _gelu(x):
    return torch.nn.functional.gelu(x, approximate='tanh')

def _silu(x):
    return torch.nn.functional.silu(x)

def _sigmoid(x):
    return torch.sigmoid(x)

def _layernorm(x, axis=-1, eps=1e-05):
    m = x.mean(dim=axis, keepdim=True)
    v = x.var(dim=axis, keepdim=True, unbiased=False)
    return (x - m) / torch.sqrt(v + eps)

def _scatter_add(tgt, idx, src, axis=0):
    return tgt.clone().index_add_(axis, idx, src)

def _segment_sum(src, seg, n):
    out = torch.zeros((n,) + src.shape[1:], dtype=src.dtype)
    return out.index_add_(0, seg, src)

def _pad(x, pw):
    flat = tuple((v for pair in reversed(pw) for v in pair))
    return torch.nn.functional.pad(x, flat)
kernel_name = 'gather_scatter__tensor_product_equiv_equiformer__graph'

def setup_inputs():

    _w = lambda a: (lambda t: t.to(torch.bfloat16) if t.is_floating_point() else t)(torch.as_tensor(a))
    N, deg, C, De = (10000, 64, 64, max(4, 1))
    E = N * deg
    src = (lambda lo, hi, *s: torch.randint(lo, hi, s))(0, N, E).to(torch.int64)
    dst = (lambda lo, hi, *s: torch.randint(lo, hi, s))(0, N, E).to(torch.int64)
    rvec = (lambda *s: torch.randn(*s, dtype=torch.bfloat16) * 0.05)(E, 3).to(float)
    rn = (torch.linalg.norm(rvec, dim=-1, keepdim=True) + 1e-06).to(float)
    rhat = (rvec / rn).to(float)
    eps = torch.zeros((3, 3, 3), dtype=float)
    eps[0, 1, 2] = eps[1, 2, 0] = eps[2, 0, 1] = 1.0
    eps[0, 2, 1] = eps[2, 1, 0] = eps[1, 0, 2] = -1.0
    return {'x': _w((lambda *s: torch.randn(*s, dtype=torch.bfloat16) * 0.4)(N, 4 * C).to(float)), 'rhat': _w(rhat), 'e_attr': _w((lambda *s: torch.randn(*s, dtype=torch.bfloat16) * 0.4)(E, De).to(float)), 'src': _w(src), 'dst': _w(dst), 'w_rad': _w((lambda *s: torch.randn(*s, dtype=torch.bfloat16) * 0.4)(De, 5 * C).to(float)), 'w_si0': _w((lambda *s: torch.randn(*s, dtype=torch.bfloat16) * 0.4)(2 * C, C).to(float)), 'w_si1': _w((lambda *s: torch.randn(*s, dtype=torch.bfloat16) * 0.05)(3 * C, C).to(float)), 'cg_eps': _w(eps)}

def reference(x, rhat, e_attr, src, dst, w_rad, w_si0, w_si1, cg_eps):
    N = x.shape[0]
    C = w_si0.shape[1]
    E = rhat.shape[0]
    x0 = x[:, :C].clone()
    x1 = x[:, C:].reshape(N, 3, C)
    R = (e_attr @ w_rad).reshape(E, 5, C)
    f0 = x0[src]
    f1 = x1[src]
    Y1 = rhat
    p00_0 = f0 * R[:, 0, :]
    p11_0 = torch.einsum('ejc,ej->ec', f1, Y1) * R[:, 1, :]
    p01_1 = torch.einsum('ec,ej->ejc', f0, Y1) * R[:, 2, :][:, None, :]
    p10_1 = f1 * R[:, 3, :][:, None, :]
    p11_1 = torch.einsum('ijk,ekc,ej->eic', cg_eps, f1, Y1) * R[:, 4, :][:, None, :]
    m0 = torch.concatenate([p00_0, p11_0], axis=-1) @ w_si0
    m1 = torch.einsum('ejp,pc->ejc', torch.concatenate([p01_1, p10_1, p11_1], axis=-1), w_si1)
    agg0 = _segment_sum(m0, dst, N)
    agg1 = _segment_sum(m1.reshape(E, 3 * C), dst, N).reshape(N, 3, C)
    gate = _sigmoid(agg0)
    out1 = agg1 * gate[:, None, :]
    return torch.concatenate([agg0, out1.reshape(N, 3 * C)], axis=-1)
```

```asm
; @launch kernel=gs_part_kernel grid=(256,1,1) block=(640,1,1) lds=45568
; @launch kernel=gather_scatter__tensor_product_equiv_equiformer__graph_kernel grid=(250,1,1) block=(512,1,1) lds=162560
.amdgcn_target "amdgcn-amd-amdhsa--gfx950"
.text
  .globl gs_part_kernel
  .p2align 8
  .type gs_part_kernel,@function
gs_part_kernel:
  s_cmp_ge_u32 s2, 256
  s_cbranch_scc1 k1_end
  s_load_dwordx4 s[4:7], s[0:1], 0
  s_load_dwordx4 s[8:11], s[0:1], 16
  s_load_dwordx4 s[12:15], s[0:1], 32
  s_load_dwordx4 s[16:19], s[0:1], 48
  s_load_dwordx2 s[20:21], s[0:1], 88
  s_cmp_ge_u32 s2, 250
  s_cbranch_scc1 k1_prep
  s_lshr_b32 s61, s2, 3
  s_and_b32 s60, s2, 7
  s_lshr_b32 s61, s2, 3
  s_mul_i32 s2, s60, 31
  s_min_u32 s60, s60, 2
  s_add_u32 s2, s2, s60
  s_add_u32 s2, s2, s61
  v_lshlrev_b32 v1, 3, v0
  v_lshlrev_b32 v2, 4, v0
  v_mul_u32_u24 v3, 12, v0
  v_lshlrev_b32 v4, 5, v0
  v_lshlrev_b32 v5, 2, v0
  s_mul_i32 s48, s2, 10240
  s_add_u32 s49, s48, 5120
  s_mul_i32 s50, s2, 20480
  s_add_u32 s51, s50, 10240
  s_mul_i32 s52, s2, 15360
  s_add_u32 s53, s52, 7680
  v_mov_b32 v6, 0
  v_cmp_gt_u32 vcc, 256, v0
  s_and_saveexec_b64 s[54:55], vcc
  s_cbranch_execz k1_z
  ds_write_b32 v5, v6 offset:0
k1_z:
  s_or_b64 exec, exec, s[54:55]
  s_waitcnt lgkmcnt(0)
  s_mov_b32 s24, s4
  s_mov_b32 s25, s5
  s_mov_b32 s26, 5120000
  s_mov_b32 s27, 0x20000
  s_mov_b32 s28, s6
  s_mov_b32 s29, s7
  s_mov_b32 s30, 3840000
  s_mov_b32 s31, 0x20000
  s_mov_b32 s32, s8
  s_mov_b32 s33, s9
  s_mov_b32 s34, 5120000
  s_mov_b32 s35, 0x20000
  s_mov_b32 s36, s10
  s_mov_b32 s37, s11
  s_mov_b32 s38, 2560000
  s_mov_b32 s39, 0x20000
  s_mov_b32 s40, s12
  s_mov_b32 s41, s13
  s_mov_b32 s42, 2560000
  s_mov_b32 s43, 0x20000
  s_mov_b32 s44, s20
  s_mov_b32 s45, s21
  s_mov_b32 s46, 11288576
  s_mov_b32 s47, 0x20000
  buffer_load_dwordx2 v[10:11], v1, s[40:43], s48 offen
  buffer_load_dwordx2 v[12:13], v1, s[40:43], s49 offen
  buffer_load_dwordx2 v[14:15], v1, s[36:39], s48 offen
  buffer_load_dwordx2 v[16:17], v1, s[36:39], s49 offen
  s_barrier
  buffer_load_dwordx2 v[20:21], v2, s[32:35], s50 offen
  buffer_load_dwordx2 v[24:25], v2, s[32:35], s50 offen offset:8
  buffer_load_dwordx2 v[100:101], v2, s[32:35], s51 offen
  buffer_load_dwordx2 v[104:105], v2, s[32:35], s51 offen offset:8
  buffer_load_dwordx3 v[28:30], v3, s[28:31], s52 offen
  buffer_load_dwordx3 v[32:34], v3, s[28:31], s53 offen
  v_mov_b32 v7, 1
  s_waitcnt vmcnt(6)
  v_mul_u32_u24 v44, 0xcccd, v10
  v_lshrrev_b32 v44, 21, v44
  v_mul_u32_u24 v8, 40, v44
  v_sub_u32 v8, v10, v8
  v_and_b32 v9, 7, v8
  v_lshrrev_b32 v8, 3, v8
  v_lshl_add_u32 v48, v9, 3, v8
  v_lshlrev_b32 v44, 2, v44
  ds_add_rtn_u32 v52, v44, v7 offset:0
  v_mul_u32_u24 v45, 0xcccd, v11
  v_lshrrev_b32 v45, 21, v45
  v_mul_u32_u24 v8, 40, v45
  v_sub_u32 v8, v11, v8
  v_and_b32 v9, 7, v8
  v_lshrrev_b32 v8, 3, v8
  v_lshl_add_u32 v49, v9, 3, v8
  v_lshlrev_b32 v45, 2, v45
  ds_add_rtn_u32 v53, v45, v7 offset:0
  v_mul_u32_u24 v46, 0xcccd, v12
  v_lshrrev_b32 v46, 21, v46
  v_mul_u32_u24 v8, 40, v46
  v_sub_u32 v8, v12, v8
  v_and_b32 v9, 7, v8
  v_lshrrev_b32 v8, 3, v8
  v_lshl_add_u32 v50, v9, 3, v8
  v_lshlrev_b32 v46, 2, v46
  ds_add_rtn_u32 v54, v46, v7 offset:0
  v_mul_u32_u24 v47, 0xcccd, v13
  v_lshrrev_b32 v47, 21, v47
  v_mul_u32_u24 v8, 40, v47
  v_sub_u32 v8, v13, v8
  v_and_b32 v9, 7, v8
  v_lshrrev_b32 v8, 3, v8
  v_lshl_add_u32 v51, v9, 3, v8
  v_lshlrev_b32 v47, 2, v47
  ds_add_rtn_u32 v55, v47, v7 offset:0
  s_waitcnt lgkmcnt(0)
  s_barrier
  v_and_b32 v56, 63, v0
  v_lshlrev_b32 v57, 4, v56
  ds_read_b128 v[60:63], v57 offset:0
  s_waitcnt lgkmcnt(0)
  v_add_u32 v58, v60, v61
  v_add_u32 v59, v62, v63
  v_add_u32 v58, v58, v59
  v_mov_b32 v59, v58
  s_nop 1
  v_add_u32_dpp v59, v59, v59 row_shr:1 row_mask:0xf bank_mask:0xf bound_ctrl:1
  s_nop 1
  v_add_u32_dpp v59, v59, v59 row_shr:2 row_mask:0xf bank_mask:0xf bound_ctrl:1
  s_nop 1
  v_add_u32_dpp v59, v59, v59 row_shr:4 row_mask:0xf bank_mask:0xf bound_ctrl:1
  s_nop 1
  v_add_u32_dpp v59, v59, v59 row_shr:8 row_mask:0xf bank_mask:0xf bound_ctrl:1
  s_nop 1
  v_add_u32_dpp v59, v59, v59 row_bcast:15 row_mask:0xa bank_mask:0xf
  s_nop 1
  v_add_u32_dpp v59, v59, v59 row_bcast:31 row_mask:0xc bank_mask:0xf
  v_sub_u32 v64, v59, v58
  v_add_u32 v65, v64, v60
  v_add_u32 v66, v65, v61
  v_add_u32 v67, v66, v62
  ds_write_b128 v57, v[64:67] offset:1024
  v_lshrrev_b32 v8, 6, v0
  s_nop 0
  v_readfirstlane_b32 s56, v8
  s_lshl_b32 s57, s2, 10
  s_cmp_lg_u32 s56, 0
  s_cbranch_scc1 k1_notab
  v_lshl_or_b32 v68, v60, 16, v64
  v_lshl_or_b32 v69, v61, 16, v65
  v_lshl_or_b32 v70, v62, 16, v66
  v_lshl_or_b32 v71, v63, 16, v67
  buffer_store_dwordx4 v[68:71], v57, s[44:47], s57 offen offset:0 sc1
k1_notab:
  s_waitcnt lgkmcnt(0)
  ds_read_b32 v72, v44 offset:1024
  ds_read_b32 v73, v45 offset:1024
  ds_read_b32 v74, v46 offset:1024
  ds_read_b32 v75, v47 offset:1024
  s_waitcnt lgkmcnt(0)
  v_add_u32 v72, v72, v52
  v_add_u32 v73, v73, v53
  v_add_u32 v74, v74, v54
  v_add_u32 v75, v75, v55
  v_add_u32 v8, 2048, v72
  ds_write_b8 v8, v48
  v_lshlrev_b32 v72, 4, v72
  v_add_u32 v72, 4608, v72
  v_add_u32 v8, 2048, v73
  ds_write_b8 v8, v49
  v_lshlrev_b32 v73, 4, v73
  v_add_u32 v73, 4608, v73
  v_add_u32 v8, 2048, v74
  ds_write_b8 v8, v50
  v_lshlrev_b32 v74, 4, v74
  v_add_u32 v74, 4608, v74
  v_add_u32 v8, 2048, v75
  ds_write_b8 v8, v51
  v_lshlrev_b32 v75, 4, v75
  v_add_u32 v75, 4608, v75
  s_waitcnt vmcnt(0)
  v_alignbit_b32 v26, v30, v29, 16
  v_alignbit_b32 v27, v15, v30, 16
  v_mov_b32 v22, v28
  v_and_b32 v29, 0xffff, v29
  v_lshl_or_b32 v23, v14, 16, v29
  ds_write_b128 v72, v[20:23]
  ds_write_b128 v73, v[24:27]
  v_alignbit_b32 v106, v34, v33, 16
  v_alignbit_b32 v107, v17, v34, 16
  v_mov_b32 v102, v32
  v_and_b32 v33, 0xffff, v33
  v_lshl_or_b32 v103, v16, 16, v33
  ds_write_b128 v74, v[100:103]
  ds_write_b128 v75, v[104:107]
  s_waitcnt lgkmcnt(0)
  s_barrier
  ds_read_b128 v[80:83], v2 offset:4608
  ds_read_b128 v[84:87], v2 offset:14848
  ds_read_b128 v[88:91], v2 offset:25088
  ds_read_b128 v[92:95], v2 offset:35328
  ds_read_b32 v96, v5 offset:2048
  s_mul_i32 s58, s2, 40960
  s_add_u32 s58, s58, 1048576
  s_mul_i32 s59, s2, 2560
  s_add_u32 s59, s59, 327680
  s_waitcnt lgkmcnt(4)
  buffer_store_dwordx4 v[80:83], v2, s[44:47], s58 offen sc1
  s_add_u32 s58, s58, 10240
  s_waitcnt lgkmcnt(3)
  buffer_store_dwordx4 v[84:87], v2, s[44:47], s58 offen sc1
  s_add_u32 s58, s58, 10240
  s_waitcnt lgkmcnt(2)
  buffer_store_dwordx4 v[88:91], v2, s[44:47], s58 offen sc1
  s_add_u32 s58, s58, 10240
  s_waitcnt lgkmcnt(1)
  buffer_store_dwordx4 v[92:95], v2, s[44:47], s58 offen sc1
  s_waitcnt lgkmcnt(0)
  buffer_store_dword v96, v5, s[44:47], s59 offen sc1
  s_endpgm
k1_prep:
  s_waitcnt lgkmcnt(0)
  s_mov_b32 s24, s14
  s_mov_b32 s25, s15
  s_mov_b32 s26, 2560
  s_mov_b32 s27, 0x20000
  s_mov_b32 s28, s16
  s_mov_b32 s29, s17
  s_mov_b32 s30, 16384
  s_mov_b32 s31, 0x20000
  s_mov_b32 s32, s18
  s_mov_b32 s33, s19
  s_mov_b32 s34, 24576
  s_mov_b32 s35, 0x20000
  s_mov_b32 s44, s20
  s_mov_b32 s45, s21
  s_mov_b32 s46, 11288576
  s_mov_b32 s47, 0x20000
  s_cmp_eq_u32 s2, 255
  s_cbranch_scc1 k1_lc
  s_cmp_lg_u32 s2, 250
  s_cbranch_scc1 k1_frag
  v_mov_b32 v1, 0
  v_lshlrev_b32 v2, 2, v0
  s_mov_b32 s58, 256000
  buffer_store_dword v1, v2, s[44:47], s58 offen sc1
  buffer_store_dword v1, v2, s[44:47], s58 offen offset:2560 sc1
  v_cmp_gt_u32 vcc, 256, v0
  s_and_saveexec_b64 s[54:55], vcc
  s_cbranch_execz k1_zt
  s_add_u32 s58, s58, 5120
  buffer_store_dword v1, v2, s[44:47], s58 offen sc1
k1_zt:
  s_or_b64 exec, exec, s[54:55]
  v_add_u32 v1, 0, v0
  v_lshrrev_b32 v2, 10, v1
  v_bfe_u32 v3, v1, 8, 2
  v_bfe_u32 v4, v1, 2, 4
  v_bfe_u32 v5, v1, 6, 2
  v_and_b32 v6, 3, v1
  v_lshl_add_u32 v7, v3, 4, v4
  v_mov_b32 v8, 4
  v_cmp_eq_u32 vcc, v5, v2
  s_nop 1
  v_cndmask_b32 v8, v8, 1, vcc
  v_cmp_eq_u32 vcc, 0, v5
  s_nop 1
  v_cndmask_b32 v8, v8, 3, vcc
  v_mov_b32 v9, 2
  v_cmp_eq_u32 vcc, 0, v5
  s_nop 1
  v_cndmask_b32 v9, v9, 0, vcc
  v_cmp_eq_u32 vcc, 0, v2
  s_nop 1
  v_cndmask_b32 v8, v8, v9, vcc
  v_mul_u32_u24 v10, 320, v6
  v_lshl_add_u32 v10, v8, 6, v10
  v_add_u32 v10, v10, v7
  v_lshlrev_b32 v10, 1, v10
  buffer_load_ushort v20, v10, s[24:27], 0 offen
  v_subrev_u32 v12, 1, v2
  v_mov_b32 v13, v5
  v_cmp_eq_u32 vcc, 3, v5
  s_nop 1
  v_cndmask_b32 v13, v13, 0, vcc
  v_cmp_ne_u32 vcc, v12, v13
  v_cmp_eq_u32 s[56:57], 4, v8
  s_nop 1
  s_and_b64 vcc, vcc, s[56:57]
  v_mov_b32 v14, 0
  v_mov_b32 v15, 0x80000000
  s_nop 1
  v_cndmask_b32 v30, v14, v15, vcc
  v_add_u32 v1, 640, v0
  v_lshrrev_b32 v2, 10, v1
  v_bfe_u32 v3, v1, 8, 2
  v_bfe_u32 v4, v1, 2, 4
  v_bfe_u32 v5, v1, 6, 2
  v_and_b32 v6, 3, v1
  v_lshl_add_u32 v7, v3, 4, v4
  v_mov_b32 v8, 4
  v_cmp_eq_u32 vcc, v5, v2
  s_nop 1
  v_cndmask_b32 v8, v8, 1, vcc
  v_cmp_eq_u32 vcc, 0, v5
  s_nop 1
  v_cndmask_b32 v8, v8, 3, vcc
  v_mov_b32 v9, 2
  v_cmp_eq_u32 vcc, 0, v5
  s_nop 1
  v_cndmask_b32 v9, v9, 0, vcc
  v_cmp_eq_u32 vcc, 0, v2
  s_nop 1
  v_cndmask_b32 v8, v8, v9, vcc
  v_mul_u32_u24 v10, 320, v6
  v_lshl_add_u32 v10, v8, 6, v10
  v_add_u32 v10, v10, v7
  v_lshlrev_b32 v10, 1, v10
  buffer_load_ushort v21, v10, s[24:27], 0 offen
  v_subrev_u32 v12, 1, v2
  v_mov_b32 v13, v5
  v_cmp_eq_u32 vcc, 3, v5
  s_nop 1
  v_cndmask_b32 v13, v13, 0, vcc
  v_cmp_ne_u32 vcc, v12, v13
  v_cmp_eq_u32 s[56:57], 4, v8
  s_nop 1
  s_and_b64 vcc, vcc, s[56:57]
  v_mov_b32 v14, 0
  v_mov_b32 v15, 0x80000000
  s_nop 1
  v_cndmask_b32 v31, v14, v15, vcc
  v_add_u32 v1, 1280, v0
  v_lshrrev_b32 v2, 10, v1
  v_bfe_u32 v3, v1, 8, 2
  v_bfe_u32 v4, v1, 2, 4
  v_bfe_u32 v5, v1, 6, 2
  v_and_b32 v6, 3, v1
  v_lshl_add_u32 v7, v3, 4, v4
  v_mov_b32 v8, 4
  v_cmp_eq_u32 vcc, v5, v2
  s_nop 1
  v_cndmask_b32 v8, v8, 1, vcc
  v_cmp_eq_u32 vcc, 0, v5
  s_nop 1
  v_cndmask_b32 v8, v8, 3, vcc
  v_mov_b32 v9, 2
  v_cmp_eq_u32 vcc, 0, v5
  s_nop 1
  v_cndmask_b32 v9, v9, 0, vcc
  v_cmp_eq_u32 vcc, 0, v2
  s_nop 1
  v_cndmask_b32 v8, v8, v9, vcc
  v_mul_u32_u24 v10, 320, v6
  v_lshl_add_u32 v10, v8, 6, v10
  v_add_u32 v10, v10, v7
  v_lshlrev_b32 v10, 1, v10
  buffer_load_ushort v22, v10, s[24:27], 0 offen
  v_subrev_u32 v12, 1, v2
  v_mov_b32 v13, v5
  v_cmp_eq_u32 vcc, 3, v5
  s_nop 1
  v_cndmask_b32 v13, v13, 0, vcc
  v_cmp_ne_u32 vcc, v12, v13
  v_cmp_eq_u32 s[56:57], 4, v8
  s_nop 1
  s_and_b64 vcc, vcc, s[56:57]
  v_mov_b32 v14, 0
  v_mov_b32 v15, 0x80000000
  s_nop 1
  v_cndmask_b32 v32, v14, v15, vcc
  v_add_u32 v1, 1920, v0
  v_lshrrev_b32 v2, 10, v1
  v_bfe_u32 v3, v1, 8, 2
  v_bfe_u32 v4, v1, 2, 4
  v_bfe_u32 v5, v1, 6, 2
  v_and_b32 v6, 3, v1
  v_lshl_add_u32 v7, v3, 4, v4
  v_mov_b32 v8, 4
  v_cmp_eq_u32 vcc, v5, v2
  s_nop 1
  v_cndmask_b32 v8, v8, 1, vcc
  v_cmp_eq_u32 vcc, 0, v5
  s_nop 1
  v_cndmask_b32 v8, v8, 3, vcc
  v_mov_b32 v9, 2
  v_cmp_eq_u32 vcc, 0, v5
  s_nop 1
  v_cndmask_b32 v9, v9, 0, vcc
  v_cmp_eq_u32 vcc, 0, v2
  s_nop 1
  v_cndmask_b32 v8, v8, v9, vcc
  v_mul_u32_u24 v10, 320, v6
  v_lshl_add_u32 v10, v8, 6, v10
  v_add_u32 v10, v10, v7
  v_lshlrev_b32 v10, 1, v10
  buffer_load_ushort v23, v10, s[24:27], 0 offen
  v_subrev_u32 v12, 1, v2
  v_mov_b32 v13, v5
  v_cmp_eq_u32 vcc, 3, v5
  s_nop 1
  v_cndmask_b32 v13, v13, 0, vcc
  v_cmp_ne_u32 vcc, v12, v13
  v_cmp_eq_u32 s[56:57], 4, v8
  s_nop 1
  s_and_b64 vcc, vcc, s[56:57]
  v_mov_b32 v14, 0
  v_mov_b32 v15, 0x80000000
  s_nop 1
  v_cndmask_b32 v33, v14, v15, vcc
  v_add_u32 v1, 2560, v0
  v_lshrrev_b32 v2, 10, v1
  v_bfe_u32 v3, v1, 8, 2
  v_bfe_u32 v4, v1, 2, 4
  v_bfe_u32 v5, v1, 6, 2
  v_and_b32 v6, 3, v1
  v_lshl_add_u32 v7, v3, 4, v4
  v_mov_b32 v8, 4
  v_cmp_eq_u32 vcc, v5, v2
  s_nop 1
  v_cndmask_b32 v8, v8, 1, vcc
  v_cmp_eq_u32 vcc, 0, v5
  s_nop 1
  v_cndmask_b32 v8, v8, 3, vcc
  v_mov_b32 v9, 2
  v_cmp_eq_u32 vcc, 0, v5
  s_nop 1
  v_cndmask_b32 v9, v9, 0, vcc
  v_cmp_eq_u32 vcc, 0, v2
  s_nop 1
  v_cndmask_b32 v8, v8, v9, vcc
  v_mul_u32_u24 v10, 320, v6
  v_lshl_add_u32 v10, v8, 6, v10
  v_add_u32 v10, v10, v7
  v_lshlrev_b32 v10, 1, v10
  buffer_load_ushort v24, v10, s[24:27], 0 offen
  v_subrev_u32 v12, 1, v2
  v_mov_b32 v13, v5
  v_cmp_eq_u32 vcc, 3, v5
  s_nop 1
  v_cndmask_b32 v13, v13, 0, vcc
  v_cmp_ne_u32 vcc, v12, v13
  v_cmp_eq_u32 s[56:57], 4, v8
  s_nop 1
  s_and_b64 vcc, vcc, s[56:57]
  v_mov_b32 v14, 0
  v_mov_b32 v15, 0x80000000
  s_nop 1
  v_cndmask_b32 v34, v14, v15, vcc
  v_add_u32 v1, 3200, v0
  v_lshrrev_b32 v2, 10, v1
  v_bfe_u32 v3, v1, 8, 2
  v_bfe_u32 v4, v1, 2, 4
  v_bfe_u32 v5, v1, 6, 2
  v_and_b32 v6, 3, v1
  v_lshl_add_u32 v7, v3, 4, v4
  v_mov_b32 v8, 4
  v_cmp_eq_u32 vcc, v5, v2
  s_nop 1
  v_cndmask_b32 v8, v8, 1, vcc
  v_cmp_eq_u32 vcc, 0, v5
  s_nop 1
  v_cndmask_b32 v8, v8, 3, vcc
  v_mov_b32 v9, 2
  v_cmp_eq_u32 vcc, 0, v5
  s_nop 1
  v_cndmask_b32 v9, v9, 0, vcc
  v_cmp_eq_u32 vcc, 0, v2
  s_nop 1
  v_cndmask_b32 v8, v8, v9, vcc
  v_mul_u32_u24 v10, 320, v6
  v_lshl_add_u32 v10, v8, 6, v10
  v_add_u32 v10, v10, v7
  v_lshlrev_b32 v10, 1, v10
  buffer_load_ushort v25, v10, s[24:27], 0 offen
  v_subrev_u32 v12, 1, v2
  v_mov_b32 v13, v5
  v_cmp_eq_u32 vcc, 3, v5
  s_nop 1
  v_cndmask_b32 v13, v13, 0, vcc
  v_cmp_ne_u32 vcc, v12, v13
  v_cmp_eq_u32 s[56:57], 4, v8
  s_nop 1
  s_and_b64 vcc, vcc, s[56:57]
  v_mov_b32 v14, 0
  v_mov_b32 v15, 0x80000000
  s_nop 1
  v_cndmask_b32 v35, v14, v15, vcc
  v_add_u32 v1, 3840, v0
  v_cmp_gt_u32 vcc, 4096, v1
  s_and_saveexec_b64 s[54:55], vcc
  v_lshrrev_b32 v2, 10, v1
  v_bfe_u32 v3, v1, 8, 2
  v_bfe_u32 v4, v1, 2, 4
  v_bfe_u32 v5, v1, 6, 2
  v_and_b32 v6, 3, v1
  v_lshl_add_u32 v7, v3, 4, v4
  v_mov_b32 v8, 4
  v_cmp_eq_u32 vcc, v5, v2
  s_nop 1
  v_cndmask_b32 v8, v8, 1, vcc
  v_cmp_eq_u32 vcc, 0, v5
  s_nop 1
  v_cndmask_b32 v8, v8, 3, vcc
  v_mov_b32 v9, 2
  v_cmp_eq_u32 vcc, 0, v5
  s_nop 1
  v_cndmask_b32 v9, v9, 0, vcc
  v_cmp_eq_u32 vcc, 0, v2
  s_nop 1
  v_cndmask_b32 v8, v8, v9, vcc
  v_mul_u32_u24 v10, 320, v6
  v_lshl_add_u32 v10, v8, 6, v10
  v_add_u32 v10, v10, v7
  v_lshlrev_b32 v10, 1, v10
  buffer_load_ushort v26, v10, s[24:27], 0 offen
  v_subrev_u32 v12, 1, v2
  v_mov_b32 v13, v5
  v_cmp_eq_u32 vcc, 3, v5
  s_nop 1
  v_cndmask_b32 v13, v13, 0, vcc
  v_cmp_ne_u32 vcc, v12, v13
  v_cmp_eq_u32 s[56:57], 4, v8
  s_nop 1
  s_and_b64 vcc, vcc, s[56:57]
  v_mov_b32 v14, 0
  v_mov_b32 v15, 0x80000000
  s_nop 1
  v_cndmask_b32 v36, v14, v15, vcc
  s_mov_b64 s[60:61], exec
  s_mov_b64 exec, s[54:55]
  v_lshlrev_b32 v1, 2, v0
  s_mov_b32 s58, 262144
  s_waitcnt vmcnt(0)
  v_lshlrev_b32 v20, 16, v20
  v_xor_b32 v20, v20, v30
  buffer_store_dword v20, v1, s[44:47], s58 offen sc1
  s_add_u32 s58, s58, 2560
  v_lshlrev_b32 v21, 16, v21
  v_xor_b32 v21, v21, v31
  buffer_store_dword v21, v1, s[44:47], s58 offen sc1
  s_add_u32 s58, s58, 2560
  v_lshlrev_b32 v22, 16, v22
  v_xor_b32 v22, v22, v32
  buffer_store_dword v22, v1, s[44:47], s58 offen sc1
  s_add_u32 s58, s58, 2560
  v_lshlrev_b32 v23, 16, v23
  v_xor_b32 v23, v23, v33
  buffer_store_dword v23, v1, s[44:47], s58 offen sc1
  s_add_u32 s58, s58, 2560
  v_lshlrev_b32 v24, 16, v24
  v_xor_b32 v24, v24, v34
  buffer_store_dword v24, v1, s[44:47], s58 offen sc1
  s_add_u32 s58, s58, 2560
  v_lshlrev_b32 v25, 16, v25
  v_xor_b32 v25, v25, v35
  buffer_store_dword v25, v1, s[44:47], s58 offen sc1
  s_add_u32 s58, s58, 2560
  s_mov_b64 exec, s[60:61]
  v_lshlrev_b32 v26, 16, v26
  v_xor_b32 v26, v26, v36
  buffer_store_dword v26, v1, s[44:47], s58 offen sc1
  s_add_u32 s58, s58, 2560
  s_endpgm
k1_lc:
  v_cmp_gt_u32 vcc, 528, v0
  s_and_saveexec_b64 s[54:55], vcc
  s_cbranch_execz k1_lc1
  v_lshrrev_b32 v11, 4, v0
  v_lshlrev_b32 v12, 3, v0
  v_and_b32 v12, 16, v12
  v_and_b32 v13, 12, v0
  v_or_b32 v12, v12, v13
  v_lshlrev_b32 v13, 1, v0
  v_and_b32 v13, 2, v13
  v_or_b32 v12, v12, v13
  v_sub_u32 v11, v11, v12
  v_med3_i32 v11, v11, 0, 2
  v_lshlrev_b32 v11, 4, v11
  v_mov_b32 v12, -1
  v_sub_u32 v11, 32, v11
  v_mov_b32 v13, 0
  v_cmp_gt_u32 vcc, 32, v11
  v_lshrrev_b32 v12, v11, v12
  v_lshlrev_b32 v10, 2, v0
  v_cndmask_b32 v12, v13, v12, vcc
  s_mov_b32 s58, 324608
  buffer_store_dword v12, v10, s[44:47], s58 offen sc1
k1_lc1:
  s_or_b64 exec, exec, s[54:55]
  v_cmp_gt_u32 vcc, 64, v0
  s_and_saveexec_b64 s[54:55], vcc
  s_cbranch_execz k1_end
  v_lshrrev_b32 v10, 3, v0
  v_and_b32 v11, 7, v0
  v_and_b32 v12, 6, v10
  v_xor_b32 v11, v11, v12
  v_lshlrev_b32 v36, 4, v11
  v_and_b32 v11, 3, v0
  v_lshl_add_u32 v10, v11, 3, v10
  v_lshlrev_b32 v27, 4, v10
  v_add_u32 v27, 14, v27
  v_lshrrev_b32 v10, 2, v0
  v_and_b32 v11, 3, v0
  v_lshlrev_b32 v12, 7, v10
  v_lshl_add_u32 v12, v11, 3, v12
  v_lshlrev_b32 v13, 4, v10
  v_and_b32 v13, 0x60, v13
  v_xor_b32 v14, 0, v13
  v_add_u32 v20, v12, v14
  v_xor_b32 v14, 32, v13
  v_add_u32 v21, v12, v14
  v_xor_b32 v14, 64, v13
  v_add_u32 v22, v12, v14
  v_xor_b32 v14, 96, v13
  v_add_u32 v23, v12, v14
  v_lshrrev_b32 v10, 4, v0
  v_lshlrev_b32 v37, 4, v10
  v_add_u32 v37, 2048, v37
  v_and_b32 v11, 15, v0
  v_lshrrev_b32 v12, 1, v10
  v_lshl_add_u32 v12, v12, 4, v11
  v_lshlrev_b32 v38, 4, v12
  v_mov_b32 v39, 0
  v_and_b32 v12, 1, v10
  v_cmp_eq_u32 vcc, 1, v12
  v_mov_b32 v13, 0
  v_mov_b32 v14, 0xffff0000
  v_mov_b32 v15, 0x3f800000
  v_cndmask_b32 v24, v13, v14, vcc
  v_cndmask_b32 v25, v15, v13, vcc
  v_mov_b32 v14, 0x01000c0c
  v_mov_b32 v15, 0x05040c0c
  v_cndmask_b32 v26, v14, v15, vcc
  v_lshrrev_b32 v14, 3, v11
  v_cmp_eq_u32 s[56:57], v14, v12
  v_and_b32 v15, 1, v11
  v_mov_b32 v16, 0x3f80
  v_mov_b32 v17, 0x3f800000
  v_cmp_eq_u32 vcc, 1, v15
  v_bfe_u32 v14, v11, 1, 2
  s_nop 0
  v_cndmask_b32 v16, v16, v17, vcc
  v_cndmask_b32 v16, v13, v16, s[56:57]
  v_cmp_gt_u32 s[58:59], 2, v10
  v_cmp_eq_u32 vcc, 0, v14
  s_nop 1
  v_cndmask_b32 v17, v13, v16, vcc
  v_cndmask_b32 v28, v13, v17, s[58:59]
  v_cndmask_b32 v32, v17, v13, s[58:59]
  v_cmp_eq_u32 vcc, 1, v14
  s_nop 1
  v_cndmask_b32 v17, v13, v16, vcc
  v_cndmask_b32 v29, v13, v17, s[58:59]
  v_cndmask_b32 v33, v17, v13, s[58:59]
  v_cmp_eq_u32 vcc, 2, v14
  s_nop 1
  v_cndmask_b32 v17, v13, v16, vcc
  v_cndmask_b32 v30, v13, v17, s[58:59]
  v_cndmask_b32 v34, v17, v13, s[58:59]
  v_cmp_eq_u32 vcc, 3, v14
  s_nop 1
  v_cndmask_b32 v17, v13, v16, vcc
  v_cndmask_b32 v31, v13, v17, s[58:59]
  v_cndmask_b32 v35, v17, v13, s[58:59]
  v_lshlrev_b32 v1, 4, v0
  s_mov_b32 s60, 319488
  buffer_store_dwordx4 v[20:23], v1, s[44:47], s60 offen offset:0 sc1
  buffer_store_dwordx4 v[24:27], v1, s[44:47], s60 offen offset:1024 sc1
  buffer_store_dwordx4 v[28:31], v1, s[44:47], s60 offen offset:2048 sc1
  buffer_store_dwordx4 v[32:35], v1, s[44:47], s60 offen offset:3072 sc1
  s_add_u32 s60, s60, 4096
  buffer_store_dwordx4 v[36:39], v1, s[44:47], s60 offen sc1
  s_endpgm
k1_frag:
  s_sub_u32 s48, s2, 251
  v_lshrrev_b32 v1, 7, v0
  v_bfe_u32 v2, v0, 6, 1
  v_and_b32 v3, 15, v0
  v_bfe_u32 v4, v0, 4, 2
  v_lshlrev_b32 v5, 3, v2
  v_lshl_add_u32 v5, v4, 1, v5
  v_cmp_gt_u32 vcc, 2, v1
  v_subrev_u32 v6, 2, v1
  s_nop 0
  v_cndmask_b32 v6, v6, v1, vcc
  v_lshl_add_u32 v5, v6, 6, v5
  s_lshl_b32 s49, s48, 4
  v_add_u32 v3, s49, v3
  v_lshlrev_b32 v3, 1, v3
  v_lshl_add_u32 v7, v5, 7, v3
  s_mov_b64 s[56:57], vcc
  s_mov_b64 s[54:55], exec
  s_and_b64 exec, exec, s[56:57]
  s_cbranch_execz k1_fr0
  buffer_load_ushort v10, v7, s[28:31], 0 offen offset:0
  buffer_load_ushort v11, v7, s[28:31], 0 offen offset:2048
  s_mov_b32 s50, 4096
  buffer_load_ushort v12, v7, s[28:31], s50 offen
  s_mov_b32 s50, 6144
  buffer_load_ushort v13, v7, s[28:31], s50 offen
  buffer_load_ushort v14, v7, s[28:31], 0 offen offset:128
  buffer_load_ushort v15, v7, s[28:31], 0 offen offset:2176
  s_mov_b32 s50, 4224
  buffer_load_ushort v16, v7, s[28:31], s50 offen
  s_mov_b32 s50, 6272
  buffer_load_ushort v17, v7, s[28:31], s50 offen
k1_fr0:
  s_andn2_b64 exec, s[54:55], s[56:57]
  s_cbranch_execz k1_fr1
  buffer_load_ushort v10, v7, s[32:35], 0 offen offset:0
  buffer_load_ushort v11, v7, s[32:35], 0 offen offset:2048
  s_mov_b32 s50, 4096
  buffer_load_ushort v12, v7, s[32:35], s50 offen
  s_mov_b32 s50, 6144
  buffer_load_ushort v13, v7, s[32:35], s50 offen
  buffer_load_ushort v14, v7, s[32:35], 0 offen offset:128
  buffer_load_ushort v15, v7, s[32:35], 0 offen offset:2176
  s_mov_b32 s50, 4224
  buffer_load_ushort v16, v7, s[32:35], s50 offen
  s_mov_b32 s50, 6272
  buffer_load_ushort v17, v7, s[32:35], s50 offen
k1_fr1:
  s_mov_b64 exec, s[54:55]
  s_waitcnt vmcnt(0)
  v_lshl_or_b32 v20, v11, 16, v10
  v_lshl_or_b32 v21, v13, 16, v12
  v_lshl_or_b32 v22, v15, 16, v14
  v_lshl_or_b32 v23, v17, 16, v16
  v_lshlrev_b32 v8, 4, v0
  s_mul_i32 s50, s48, 10240
  s_add_u32 s50, s50, 278528
  buffer_store_dwordx4 v[20:23], v8, s[44:47], s50 offen sc1
k1_end:
  s_endpgm
.section .rodata,"a"
.p2align 6
.amdhsa_kernel gs_part_kernel
  .amdhsa_next_free_vgpr 112
  .amdhsa_next_free_sgpr 72
  .amdhsa_accum_offset 112
  .amdhsa_group_segment_fixed_size 0
  .amdhsa_kernarg_size 96
  .amdhsa_user_sgpr_count 2
  .amdhsa_user_sgpr_kernarg_segment_ptr 1
  .amdhsa_system_sgpr_workgroup_id_x 1
.end_amdhsa_kernel
.text
  .globl gather_scatter__tensor_product_equiv_equiformer__graph_kernel
  .p2align 8
  .type gather_scatter__tensor_product_equiv_equiformer__graph_kernel,@function
gather_scatter__tensor_product_equiv_equiformer__graph_kernel:
  s_cmp_ge_u32 s2, 250
  s_cbranch_scc1 k2_end
  s_load_dwordx2 s[36:37], s[0:1], 0
  s_load_dwordx2 s[38:39], s[0:1], 72
  s_load_dwordx2 s[40:41], s[0:1], 88
  s_and_b32 s34, s2, 7
  s_lshr_b32 s27, s2, 3
  s_mul_i32 s16, s34, 31
  s_min_u32 s34, s34, 2
  s_add_u32 s16, s16, s34
  s_add_u32 s16, s16, s27
  v_lshrrev_b32 v1, 6, v0
  v_and_b32 v217, 63, v0
  v_readfirstlane_b32 s17, v1
  v_lshrrev_b32 v196, 4, v0
  v_and_b32 v3, 15, v0
  v_lshlrev_b32 v197, 10, v196
  v_mul_u32_u24 v4, 2560, v196
  v_add_u32 v4, v4, v3
  v_add_u32 v5, 16, v3
  v_lshlrev_b32 v7, 2, v0
  v_mov_b32 v6, 0
  s_lshl_b32 s34, s16, 2
  v_cmp_gt_u32 vcc, 132, v0
  s_and_saveexec_b64 s[54:55], vcc
  ds_write_b32 v7, v6 offset:2112
  s_mov_b64 exec, s[54:55]
  s_waitcnt lgkmcnt(0)
  s_mov_b32 s8, s40
  s_mov_b32 s9, s41
  s_mov_b32 s10, 11288576
  s_mov_b32 s11, 0x20000
  buffer_load_dword v236, v197, s[8:11], s34 offen
  s_add_u32 s34, s34, 32768
  buffer_load_dword v237, v197, s[8:11], s34 offen
  s_add_u32 s34, s34, 32768
  buffer_load_dword v238, v197, s[8:11], s34 offen
  s_add_u32 s34, s34, 32768
  buffer_load_dword v239, v197, s[8:11], s34 offen
  s_add_u32 s34, s34, 32768
  buffer_load_dword v240, v197, s[8:11], s34 offen
  s_add_u32 s34, s34, 32768
  buffer_load_dword v241, v197, s[8:11], s34 offen
  s_add_u32 s34, s34, 32768
  buffer_load_dword v242, v197, s[8:11], s34 offen
  s_add_u32 s34, s34, 32768
  buffer_load_dword v243, v197, s[8:11], s34 offen
  s_sub_u32 s4, s36, 3072
  s_subb_u32 s5, s37, 0
  s_mov_b32 s6, 5123072
  s_mov_b32 s7, 0x20000
  s_mov_b32 s90, 3072
  s_mov_b32 s91, 2048
  s_mov_b32 s92, 1024
  s_mov_b32 s12, s38
  s_mov_b32 s13, s39
  s_mov_b32 s14, 5120000
  s_mov_b32 s15, 0x20000
  s_mov_b32 s52, 1048576
  s_mov_b32 s53, 327680
  s_mov_b32 s20, 0
  s_mov_b32 s21, 0
  v_lshlrev_b32 v198, 4, v217
  s_lshl_b32 s34, s17, 10
  s_add_u32 m0, s34, 56064
  s_add_u32 s35, s34, 262144
  buffer_load_dwordx4 v198, s[8:11], s35 offen lds
  s_add_u32 m0, s34, 154368
  s_add_u32 s35, s34, 270336
  buffer_load_dwordx4 v198, s[8:11], s35 offen lds
  s_add_u32 s35, s34, 319488
  s_add_u32 s36, s34, 64256
  s_add_u32 s37, s34, 319488
  s_add_u32 s38, s34, 4294962176
  s_cmp_gt_u32 s17, 4
  s_cselect_b32 s35, s37, s35
  s_cselect_b32 m0, s38, s36
  s_cmp_eq_u32 s17, 7
  s_cselect_b32 s36, 15, -1
  s_cselect_b32 s37, 0, -1
  s_mov_b64 exec, s[36:37]
  buffer_load_dwordx4 v198, s[8:11], s35 offen lds
  s_mov_b64 exec, -1
  v_mov_b64 v[8:9], 0
  v_mov_b64 v[10:11], 0
  v_mov_b64 v[12:13], 0
  v_mov_b64 v[14:15], 0
  v_mov_b64 v[16:17], 0
  v_mov_b64 v[18:19], 0
  v_mov_b64 v[20:21], 0
  v_mov_b64 v[22:23], 0
  v_mov_b64 v[24:25], 0
  v_mov_b64 v[26:27], 0
  v_mov_b64 v[28:29], 0
  v_mov_b64 v[30:31], 0
  v_mov_b64 v[32:33], 0
  v_mov_b64 v[34:35], 0
  v_mov_b64 v[36:37], 0
  v_mov_b64 v[38:39], 0
  v_mov_b64 v[40:41], 0
  v_mov_b64 v[42:43], 0
  v_mov_b64 v[44:45], 0
  v_mov_b64 v[46:47], 0
  v_mov_b64 v[48:49], 0
  v_mov_b64 v[50:51], 0
  v_mov_b64 v[52:53], 0
  v_mov_b64 v[54:55], 0
  v_mov_b64 v[56:57], 0
  v_mov_b64 v[58:59], 0
  v_mov_b64 v[60:61], 0
  v_mov_b64 v[62:63], 0
  v_mov_b64 v[64:65], 0
  v_mov_b64 v[66:67], 0
  v_mov_b64 v[68:69], 0
  v_mov_b64 v[70:71], 0
  v_mov_b64 v[72:73], 0
  v_mov_b64 v[74:75], 0
  v_mov_b64 v[76:77], 0
  v_mov_b64 v[78:79], 0
  v_mov_b64 v[80:81], 0
  v_mov_b64 v[82:83], 0
  v_mov_b64 v[84:85], 0
  v_mov_b64 v[86:87], 0
  s_waitcnt vmcnt(10)
  v_cmp_gt_u32_sdwa s[56:57], v236, v3 src0_sel:WORD_1 src1_sel:DWORD
  v_add_u32_sdwa v196, v236, v4 dst_sel:DWORD dst_unused:UNUSED_PAD src0_sel:WORD_0 src1_sel:DWORD
  s_mov_b64 exec, s[56:57]
  buffer_load_ubyte v152, v196, s[8:11], s53 offen
  s_mov_b64 exec, -1
  s_add_u32 s53, s53, 81920
  s_waitcnt vmcnt(10)
  v_cmp_gt_u32_sdwa s[58:59], v237, v3 src0_sel:WORD_1 src1_sel:DWORD
  v_add_u32_sdwa v196, v237, v4 dst_sel:DWORD dst_unused:UNUSED_PAD src0_sel:WORD_0 src1_sel:DWORD
  s_mov_b64 exec, s[58:59]
  buffer_load_ubyte v153, v196, s[8:11], s53 offen
  s_mov_b64 exec, -1
  s_add_u32 s53, s53, 81920
  s_waitcnt vmcnt(10)
  v_cmp_gt_u32_sdwa s[60:61], v238, v3 src0_sel:WORD_1 src1_sel:DWORD
  v_add_u32_sdwa v196, v238, v4 dst_sel:DWORD dst_unused:UNUSED_PAD src0_sel:WORD_0 src1_sel:DWORD
  s_mov_b64 exec, s[60:61]
  buffer_load_ubyte v154, v196, s[8:11], s53 offen
  s_mov_b64 exec, -1
  s_add_u32 s53, s53, 81920
  s_waitcnt vmcnt(10)
  v_cmp_gt_u32_sdwa s[62:63], v239, v3 src0_sel:WORD_1 src1_sel:DWORD
  v_add_u32_sdwa v196, v239, v4 dst_sel:DWORD dst_unused:UNUSED_PAD src0_sel:WORD_0 src1_sel:DWORD
  s_mov_b64 exec, s[62:63]
  buffer_load_ubyte v155, v196, s[8:11], s53 offen
  s_mov_b64 exec, -1
  s_add_u32 s53, s53, 81920
  s_waitcnt vmcnt(10)
  v_cmp_gt_u32_sdwa s[64:65], v240, v3 src0_sel:WORD_1 src1_sel:DWORD
  v_add_u32_sdwa v196, v240, v4 dst_sel:DWORD dst_unused:UNUSED_PAD src0_sel:WORD_0 src1_sel:DWORD
  s_mov_b64 exec, s[64:65]
  buffer_load_ubyte v156, v196, s[8:11], s53 offen
  s_mov_b64 exec, -1
  s_add_u32 s53, s53, 81920
  s_waitcnt vmcnt(10)
  v_cmp_gt_u32_sdwa s[66:67], v241, v3 src0_sel:WORD_1 src1_sel:DWORD
  v_add_u32_sdwa v196, v241, v4 dst_sel:DWORD dst_unused:UNUSED_PAD src0_sel:WORD_0 src1_sel:DWORD
  s_mov_b64 exec, s[66:67]
  buffer_load_ubyte v157, v196, s[8:11], s53 offen
  s_mov_b64 exec, -1
  s_add_u32 s53, s53, 81920
  s_waitcnt vmcnt(10)
  v_cmp_gt_u32_sdwa s[68:69], v242, v3 src0_sel:WORD_1 src1_sel:DWORD
  v_add_u32_sdwa v196, v242, v4 dst_sel:DWORD dst_unused:UNUSED_PAD src0_sel:WORD_0 src1_sel:DWORD
  s_mov_b64 exec, s[68:69]
  buffer_load_ubyte v158, v196, s[8:11], s53 offen
  s_mov_b64 exec, -1
  s_add_u32 s53, s53, 81920
  s_waitcnt vmcnt(10)
  v_cmp_gt_u32_sdwa s[70:71], v243, v3 src0_sel:WORD_1 src1_sel:DWORD
  v_add_u32_sdwa v196, v243, v4 dst_sel:DWORD dst_unused:UNUSED_PAD src0_sel:WORD_0 src1_sel:DWORD
  s_mov_b64 exec, s[70:71]
  buffer_load_ubyte v159, v196, s[8:11], s53 offen
  s_mov_b64 exec, -1
  s_mov_b32 s53, 327696
  v_cmp_gt_u32_sdwa s[72:73], v236, v5 src0_sel:WORD_1 src1_sel:DWORD
  v_add_u32_sdwa v196, v236, v4 dst_sel:DWORD dst_unused:UNUSED_PAD src0_sel:WORD_0 src1_sel:DWORD
  s_cmp_eq_u64 s[72:73], 0
  s_cbranch_scc1 k2_p1_0
  s_mov_b64 exec, s[72:73]
  buffer_load_ubyte v160, v196, s[8:11], s53 offen
  s_mov_b64 exec, -1
k2_p1_0:
  s_add_u32 s53, s53, 81920
  v_cmp_gt_u32_sdwa s[74:75], v237, v5 src0_sel:WORD_1 src1_sel:DWORD
  v_add_u32_sdwa v196, v237, v4 dst_sel:DWORD dst_unused:UNUSED_PAD src0_sel:WORD_0 src1_sel:DWORD
  s_cmp_eq_u64 s[74:75], 0
  s_cbranch_scc1 k2_p1_1
  s_mov_b64 exec, s[74:75]
  buffer_load_ubyte v161, v196, s[8:11], s53 offen
  s_mov_b64 exec, -1
k2_p1_1:
  s_add_u32 s53, s53, 81920
  v_cmp_gt_u32_sdwa s[76:77], v238, v5 src0_sel:WORD_1 src1_sel:DWORD
  v_add_u32_sdwa v196, v238, v4 dst_sel:DWORD dst_unused:UNUSED_PAD src0_sel:WORD_0 src1_sel:DWORD
  s_cmp_eq_u64 s[76:77], 0
  s_cbranch_scc1 k2_p1_2
  s_mov_b64 exec, s[76:77]
  buffer_load_ubyte v162, v196, s[8:11], s53 offen
  s_mov_b64 exec, -1
k2_p1_2:
  s_add_u32 s53, s53, 81920
  v_cmp_gt_u32_sdwa s[78:79], v239, v5 src0_sel:WORD_1 src1_sel:DWORD
  v_add_u32_sdwa v196, v239, v4 dst_sel:DWORD dst_unused:UNUSED_PAD src0_sel:WORD_0 src1_sel:DWORD
  s_cmp_eq_u64 s[78:79], 0
  s_cbranch_scc1 k2_p1_3
  s_mov_b64 exec, s[78:79]
  buffer_load_ubyte v163, v196, s[8:11], s53 offen
  s_mov_b64 exec, -1
k2_p1_3:
  s_add_u32 s53, s53, 81920
  v_cmp_gt_u32_sdwa s[80:81], v240, v5 src0_sel:WORD_1 src1_sel:DWORD
  v_add_u32_sdwa v196, v240, v4 dst_sel:DWORD dst_unused:UNUSED_PAD src0_sel:WORD_0 src1_sel:DWORD
  s_cmp_eq_u64 s[80:81], 0
  s_cbranch_scc1 k2_p1_4
  s_mov_b64 exec, s[80:81]
  buffer_load_ubyte v252, v196, s[8:11], s53 offen
  s_mov_b64 exec, -1
k2_p1_4:
  s_add_u32 s53, s53, 81920
  v_cmp_gt_u32_sdwa s[82:83], v241, v5 src0_sel:WORD_1 src1_sel:DWORD
  v_add_u32_sdwa v196, v241, v4 dst_sel:DWORD dst_unused:UNUSED_PAD src0_sel:WORD_0 src1_sel:DWORD
  s_cmp_eq_u64 s[82:83], 0
  s_cbranch_scc1 k2_p1_5
  s_mov_b64 exec, s[82:83]
  buffer_load_ubyte v253, v196, s[8:11], s53 offen
  s_mov_b64 exec, -1
k2_p1_5:
  s_add_u32 s53, s53, 81920
  v_cmp_gt_u32_sdwa s[84:85], v242, v5 src0_sel:WORD_1 src1_sel:DWORD
  v_add_u32_sdwa v196, v242, v4 dst_sel:DWORD dst_unused:UNUSED_PAD src0_sel:WORD_0 src1_sel:DWORD
  s_cmp_eq_u64 s[84:85], 0
  s_cbranch_scc1 k2_p1_6
  s_mov_b64 exec, s[84:85]
  buffer_load_ubyte v254, v196, s[8:11], s53 offen
  s_mov_b64 exec, -1
k2_p1_6:
  s_add_u32 s53, s53, 81920
  v_cmp_gt_u32_sdwa s[86:87], v243, v5 src0_sel:WORD_1 src1_sel:DWORD
  v_add_u32_sdwa v196, v243, v4 dst_sel:DWORD dst_unused:UNUSED_PAD src0_sel:WORD_0 src1_sel:DWORD
  s_cmp_eq_u64 s[86:87], 0
  s_cbranch_scc1 k2_p1_7
  s_mov_b64 exec, s[86:87]
  buffer_load_ubyte v255, v196, s[8:11], s53 offen
  s_mov_b64 exec, -1
k2_p1_7:
  v_add_u32_sdwa v196, v236, v4 dst_sel:DWORD dst_unused:UNUSED_PAD src0_sel:WORD_0 src1_sel:DWORD
  v_lshlrev_b32 v197, 4, v196
  s_mov_b64 exec, s[56:57]
  buffer_load_dwordx4 v[88:91], v197, s[8:11], s52 offen
  s_mov_b64 exec, -1
  s_add_u32 s52, s52, 1310720
  v_add_u32_sdwa v196, v237, v4 dst_sel:DWORD dst_unused:UNUSED_PAD src0_sel:WORD_0 src1_sel:DWORD
  v_lshlrev_b32 v197, 4, v196
  s_mov_b64 exec, s[58:59]
  buffer_load_dwordx4 v[92:95], v197, s[8:11], s52 offen
  s_mov_b64 exec, -1
  s_add_u32 s52, s52, 1310720
  v_add_u32_sdwa v196, v238, v4 dst_sel:DWORD dst_unused:UNUSED_PAD src0_sel:WORD_0 src1_sel:DWORD
  v_lshlrev_b32 v197, 4, v196
  s_mov_b64 exec, s[60:61]
  buffer_load_dwordx4 v[96:99], v197, s[8:11], s52 offen
  s_mov_b64 exec, -1
  s_add_u32 s52, s52, 1310720
  v_add_u32_sdwa v196, v239, v4 dst_sel:DWORD dst_unused:UNUSED_PAD src0_sel:WORD_0 src1_sel:DWORD
  v_lshlrev_b32 v197, 4, v196
  s_mov_b64 exec, s[62:63]
  buffer_load_dwordx4 v[100:103], v197, s[8:11], s52 offen
  s_mov_b64 exec, -1
  s_add_u32 s52, s52, 1310720
  v_add_u32_sdwa v196, v240, v4 dst_sel:DWORD dst_unused:UNUSED_PAD src0_sel:WORD_0 src1_sel:DWORD
  v_lshlrev_b32 v197, 4, v196
  s_mov_b64 exec, s[64:65]
  buffer_load_dwordx4 v[104:107], v197, s[8:11], s52 offen
  s_mov_b64 exec, -1
  s_add_u32 s52, s52, 1310720
  v_add_u32_sdwa v196, v241, v4 dst_sel:DWORD dst_unused:UNUSED_PAD src0_sel:WORD_0 src1_sel:DWORD
  v_lshlrev_b32 v197, 4, v196
  s_mov_b64 exec, s[66:67]
  buffer_load_dwordx4 v[108:111], v197, s[8:11], s52 offen
  s_mov_b64 exec, -1
  s_add_u32 s52, s52, 1310720
  v_add_u32_sdwa v196, v242, v4 dst_sel:DWORD dst_unused:UNUSED_PAD src0_sel:WORD_0 src1_sel:DWORD
  v_lshlrev_b32 v197, 4, v196
  s_mov_b64 exec, s[68:69]
  buffer_load_dwordx4 v[112:115], v197, s[8:11], s52 offen
  s_mov_b64 exec, -1
  s_add_u32 s52, s52, 1310720
  v_add_u32_sdwa v196, v243, v4 dst_sel:DWORD dst_unused:UNUSED_PAD src0_sel:WORD_0 src1_sel:DWORD
  v_lshlrev_b32 v197, 4, v196
  s_mov_b64 exec, s[70:71]
  buffer_load_dwordx4 v[116:119], v197, s[8:11], s52 offen
  s_mov_b64 exec, -1
  v_max3_u32 v196, v236, v237, v238
  v_max3_u32 v197, v239, v240, v241
  v_max3_u32 v196, v196, v242, v243
  v_max_u32 v196, v196, v197
  v_cmp_le_u32 vcc, 2162688, v196
  s_mov_b64 s[44:45], vcc
  s_mul_i32 s32, s17, 12288
  s_add_u32 s32, s32, 56064
  s_sub_u32 s33, s32, 128
  s_lshl_b32 s49, s17, 3
  s_mov_b32 s52, 1048832
  s_waitcnt lgkmcnt(0)
  s_barrier
  s_mov_b64 exec, s[44:45]
  v_mov_b32 v197, 2624
  v_mov_b32 v198, 1
  ds_write_b32 v197, v198
  s_mov_b64 exec, -1
  s_waitcnt vmcnt(8)
k2_rank:
  v_mov_b32 v7, 1
  s_mov_b64 exec, s[56:57]
  v_lshlrev_b32 v152, 2, v152
  ds_add_rtn_u32 v220, v152, v7 offset:2112
  s_mov_b64 exec, s[58:59]
  v_lshlrev_b32 v153, 2, v153
  ds_add_rtn_u32 v221, v153, v7 offset:2112
  s_mov_b64 exec, s[60:61]
  v_lshlrev_b32 v154, 2, v154
  ds_add_rtn_u32 v222, v154, v7 offset:2112
  s_mov_b64 exec, s[62:63]
  v_lshlrev_b32 v155, 2, v155
  ds_add_rtn_u32 v223, v155, v7 offset:2112
  s_mov_b64 exec, s[64:65]
  v_lshlrev_b32 v156, 2, v156
  ds_add_rtn_u32 v224, v156, v7 offset:2112
  s_mov_b64 exec, s[66:67]
  v_lshlrev_b32 v157, 2, v157
  ds_add_rtn_u32 v225, v157, v7 offset:2112
  s_mov_b64 exec, s[68:69]
  v_lshlrev_b32 v158, 2, v158
  ds_add_rtn_u32 v226, v158, v7 offset:2112
  s_mov_b64 exec, s[70:71]
  v_lshlrev_b32 v159, 2, v159
  ds_add_rtn_u32 v227, v159, v7 offset:2112
  s_cmp_eq_u64 s[72:73], 0
  s_cbranch_scc1 k2_rk8
  s_mov_b64 exec, s[72:73]
  v_lshlrev_b32 v160, 2, v160
  ds_add_rtn_u32 v228, v160, v7 offset:2112
k2_rk8:
  s_cmp_eq_u64 s[74:75], 0
  s_cbranch_scc1 k2_rk9
  s_mov_b64 exec, s[74:75]
  v_lshlrev_b32 v161, 2, v161
  ds_add_rtn_u32 v229, v161, v7 offset:2112
k2_rk9:
  s_cmp_eq_u64 s[76:77], 0
  s_cbranch_scc1 k2_rk10
  s_mov_b64 exec, s[76:77]
  v_lshlrev_b32 v162, 2, v162
  ds_add_rtn_u32 v230, v162, v7 offset:2112
k2_rk10:
  s_cmp_eq_u64 s[78:79], 0
  s_cbranch_scc1 k2_rk11
  s_mov_b64 exec, s[78:79]
  v_lshlrev_b32 v163, 2, v163
  ds_add_rtn_u32 v231, v163, v7 offset:2112
k2_rk11:
  s_cmp_eq_u64 s[80:81], 0
  s_cbranch_scc1 k2_rk12
  s_mov_b64 exec, s[80:81]
  v_lshlrev_b32 v252, 2, v252
  ds_add_rtn_u32 v232, v252, v7 offset:2112
k2_rk12:
  s_cmp_eq_u64 s[82:83], 0
  s_cbranch_scc1 k2_rk13
  s_mov_b64 exec, s[82:83]
  v_lshlrev_b32 v253, 2, v253
  ds_add_rtn_u32 v233, v253, v7 offset:2112
k2_rk13:
  s_cmp_eq_u64 s[84:85], 0
  s_cbranch_scc1 k2_rk14
  s_mov_b64 exec, s[84:85]
  v_lshlrev_b32 v254, 2, v254
  ds_add_rtn_u32 v234, v254, v7 offset:2112
k2_rk14:
  s_cmp_eq_u64 s[86:87], 0
  s_cbranch_scc1 k2_rk15
  s_mov_b64 exec, s[86:87]
  v_lshlrev_b32 v255, 2, v255
  ds_add_rtn_u32 v235, v255, v7 offset:2112
k2_rk15:
  s_mov_b64 exec, -1
  s_cmp_eq_u64 s[72:73], 0
  s_cbranch_scc1 k2_r1_0
  v_add_u32_sdwa v196, v236, v4 dst_sel:DWORD dst_unused:UNUSED_PAD src0_sel:WORD_0 src1_sel:DWORD
  v_lshlrev_b32 v197, 4, v196
  s_mov_b64 exec, s[72:73]
  buffer_load_dwordx4 v[120:123], v197, s[8:11], s52 offen
  s_mov_b64 exec, -1
k2_r1_0:
  s_add_u32 s52, s52, 1310720
  s_cmp_eq_u64 s[74:75], 0
  s_cbranch_scc1 k2_r1_1
  v_add_u32_sdwa v196, v237, v4 dst_sel:DWORD dst_unused:UNUSED_PAD src0_sel:WORD_0 src1_sel:DWORD
  v_lshlrev_b32 v197, 4, v196
  s_mov_b64 exec, s[74:75]
  buffer_load_dwordx4 v[124:127], v197, s[8:11], s52 offen
  s_mov_b64 exec, -1
k2_r1_1:
  s_add_u32 s52, s52, 1310720
  s_cmp_eq_u64 s[76:77], 0
  s_cbranch_scc1 k2_r1_2
  v_add_u32_sdwa v196, v238, v4 dst_sel:DWORD dst_unused:UNUSED_PAD src0_sel:WORD_0 src1_sel:DWORD
  v_lshlrev_b32 v197, 4, v196
  s_mov_b64 exec, s[76:77]
  buffer_load_dwordx4 v[128:131], v197, s[8:11], s52 offen
  s_mov_b64 exec, -1
k2_r1_2:
  s_add_u32 s52, s52, 1310720
  s_cmp_eq_u64 s[78:79], 0
  s_cbranch_scc1 k2_r1_3
  v_add_u32_sdwa v196, v239, v4 dst_sel:DWORD dst_unused:UNUSED_PAD src0_sel:WORD_0 src1_sel:DWORD
  v_lshlrev_b32 v197, 4, v196
  s_mov_b64 exec, s[78:79]
  buffer_load_dwordx4 v[132:135], v197, s[8:11], s52 offen
  s_mov_b64 exec, -1
k2_r1_3:
  s_add_u32 s52, s52, 1310720
  s_cmp_eq_u64 s[80:81], 0
  s_cbranch_scc1 k2_r1_4
  v_add_u32_sdwa v196, v240, v4 dst_sel:DWORD dst_unused:UNUSED_PAD src0_sel:WORD_0 src1_sel:DWORD
  v_lshlrev_b32 v197, 4, v196
  s_mov_b64 exec, s[80:81]
  buffer_load_dwordx4 v[136:139], v197, s[8:11], s52 offen
  s_mov_b64 exec, -1
k2_r1_4:
  s_add_u32 s52, s52, 1310720
  s_cmp_eq_u64 s[82:83], 0
  s_cbranch_scc1 k2_r1_5
  v_add_u32_sdwa v196, v241, v4 dst_sel:DWORD dst_unused:UNUSED_PAD src0_sel:WORD_0 src1_sel:DWORD
  v_lshlrev_b32 v197, 4, v196
  s_mov_b64 exec, s[82:83]
  buffer_load_dwordx4 v[140:143], v197, s[8:11], s52 offen
  s_mov_b64 exec, -1
k2_r1_5:
  s_add_u32 s52, s52, 1310720
  s_cmp_eq_u64 s[84:85], 0
  s_cbranch_scc1 k2_r1_6
  v_add_u32_sdwa v196, v242, v4 dst_sel:DWORD dst_unused:UNUSED_PAD src0_sel:WORD_0 src1_sel:DWORD
  v_lshlrev_b32 v197, 4, v196
  s_mov_b64 exec, s[84:85]
  buffer_load_dwordx4 v[144:147], v197, s[8:11], s52 offen
  s_mov_b64 exec, -1
k2_r1_6:
  s_add_u32 s52, s52, 1310720
  s_cmp_eq_u64 s[86:87], 0
  s_cbranch_scc1 k2_r1_7
  v_add_u32_sdwa v196, v243, v4 dst_sel:DWORD dst_unused:UNUSED_PAD src0_sel:WORD_0 src1_sel:DWORD
  v_lshlrev_b32 v197, 4, v196
  s_mov_b64 exec, s[86:87]
  buffer_load_dwordx4 v[148:151], v197, s[8:11], s52 offen
  s_mov_b64 exec, -1
k2_r1_7:
  s_waitcnt lgkmcnt(0)
  s_barrier
  v_lshlrev_b32 v6, 2, v217
  v_mov_b32 v203, 2624
  ds_read_b32 v196, v6 offset:2112
  ds_read_b32 v203, v203
  v_and_b32 v199, 7, v217
  v_mov_b32 v200, 0x7fffffff
  v_cmp_gt_u32 s[38:39], 5, v199
  s_waitcnt lgkmcnt(0)
  s_cmp_lg_u32 s21, 0
  s_cbranch_scc1 k2_havec
  v_lshlrev_b32 v219, 4, v217
  v_add_u32 v219, 56064, v219
  ds_read_b128 v[208:211], v219 offset:8192
  ds_read_b128 v[248:251], v219 offset:9216
  ds_read_b128 v[240:243], v219 offset:10240
  ds_read_b128 v[244:247], v219 offset:11264
  ds_read_b128 v[204:207], v219 offset:12288
  ds_read_b128 v[164:167], v219 offset:0
  ds_read_b128 v[168:171], v219 offset:1024
  ds_read_b128 v[172:175], v219 offset:2048
  ds_read_b128 v[176:179], v219 offset:3072
  ds_read_b128 v[180:183], v219 offset:4096
  ds_read_b128 v[184:187], v219 offset:5120
  ds_read_b128 v[188:191], v219 offset:6144
  ds_read_b128 v[192:195], v219 offset:7168
k2_havec:
  v_mov_b32 v198, v196
  v_readfirstlane_b32 s42, v203
  s_nop 0
  v_add_u32_dpp v198, v198, v198 row_shr:1 row_mask:0xf bank_mask:0xf bound_ctrl:1
  s_nop 1
  v_add_u32_dpp v198, v198, v198 row_shr:2 row_mask:0xf bank_mask:0xf bound_ctrl:1
  s_nop 1
  v_add_u32_dpp v198, v198, v198 row_shr:4 row_mask:0xf bank_mask:0xf bound_ctrl:1
  s_nop 1
  v_add_u32_dpp v198, v198, v198 row_shr:8 row_mask:0xf bank_mask:0xf bound_ctrl:1
  v_mov_b32 v197, 0
  s_nop 0
  v_mov_b32_dpp v197, v198 row_newbcast:7 row_mask:0xf bank_mask:0xc
  v_sub_u32 v198, v198, v197
  s_nop 1
  v_mov_b32_dpp v197, v198 row_newbcast:7 row_mask:0xf bank_mask:0x3
  v_mov_b32_dpp v197, v198 row_newbcast:15 row_mask:0xf bank_mask:0xc
  v_cndmask_b32 v215, v200, v198, s[38:39]
  v_add_u32 v201, 31, v197
  v_and_b32 v201, -32, v201
  v_cmp_eq_u32 vcc, 0, v197
  v_max_u32 v200, 96, v201
  s_nop 0
  v_cndmask_b32 v201, v200, v201, vcc
  v_mov_b32 v202, v201
  s_nop 1
  v_add_u32_dpp v202, v201, v202 row_shr:8 row_mask:0xf bank_mask:0xf bound_ctrl:1
  s_nop 1
  v_add_u32_dpp v202, v202, v202 row_bcast:15 row_mask:0xa bank_mask:0xf
  s_nop 1
  v_add_u32_dpp v202, v202, v202 row_bcast:31 row_mask:0xc bank_mask:0xf
  v_sub_u32 v199, v198, v196
  v_sub_u32 v201, v202, v201
  v_readlane_b32 s34, v202, 63
  v_add_u32 v199, v199, v201
  v_readlane_b32 s24, v201, s49
  v_readlane_b32 s25, v197, s49
  ds_write_b32 v6, v199 offset:2640
  s_cmp_gt_u32 s34, 3072
  s_cselect_b32 s42, 1, s42
  s_cmp_lg_u32 s20, 0
  s_cselect_b32 s42, 0, s42
  s_cmp_lg_u32 s42, 0
  s_cbranch_scc1 k2_slow
  s_mov_b64 exec, s[56:57]
  ds_read_b32 v152, v152 offset:2640
  s_mov_b64 exec, s[58:59]
  ds_read_b32 v153, v153 offset:2640
  s_mov_b64 exec, s[60:61]
  ds_read_b32 v154, v154 offset:2640
  s_mov_b64 exec, s[62:63]
  ds_read_b32 v155, v155 offset:2640
  s_mov_b64 exec, s[64:65]
  ds_read_b32 v156, v156 offset:2640
  s_mov_b64 exec, s[66:67]
  ds_read_b32 v157, v157 offset:2640
  s_mov_b64 exec, s[68:69]
  ds_read_b32 v158, v158 offset:2640
  s_mov_b64 exec, s[70:71]
  ds_read_b32 v159, v159 offset:2640
  s_cmp_eq_u64 s[72:73], 0
  s_cbranch_scc1 k2_bs8
  s_mov_b64 exec, s[72:73]
  ds_read_b32 v160, v160 offset:2640
k2_bs8:
  s_cmp_eq_u64 s[74:75], 0
  s_cbranch_scc1 k2_bs9
  s_mov_b64 exec, s[74:75]
  ds_read_b32 v161, v161 offset:2640
k2_bs9:
  s_cmp_eq_u64 s[76:77], 0
  s_cbranch_scc1 k2_bs10
  s_mov_b64 exec, s[76:77]
  ds_read_b32 v162, v162 offset:2640
k2_bs10:
  s_cmp_eq_u64 s[78:79], 0
  s_cbranch_scc1 k2_bs11
  s_mov_b64 exec, s[78:79]
  ds_read_b32 v163, v163 offset:2640
k2_bs11:
  s_cmp_eq_u64 s[80:81], 0
  s_cbranch_scc1 k2_bs12
  s_mov_b64 exec, s[80:81]
  ds_read_b32 v252, v252 offset:2640
k2_bs12:
  s_cmp_eq_u64 s[82:83], 0
  s_cbranch_scc1 k2_bs13
  s_mov_b64 exec, s[82:83]
  ds_read_b32 v253, v253 offset:2640
k2_bs13:
  s_cmp_eq_u64 s[84:85], 0
  s_cbranch_scc1 k2_bs14
  s_mov_b64 exec, s[84:85]
  ds_read_b32 v254, v254 offset:2640
k2_bs14:
  s_cmp_eq_u64 s[86:87], 0
  s_cbranch_scc1 k2_bs15
  s_mov_b64 exec, s[86:87]
  ds_read_b32 v255, v255 offset:2640
k2_bs15:
  s_mov_b64 exec, -1
  s_add_u32 s26, s25, 31
  s_and_b32 s26, s26, -32
  s_cmp_lt_u32 s26, 96
  s_cselect_b32 s34, 96, s26
  s_cmp_eq_u32 s25, 0
  s_cselect_b32 s26, 0, s34
  v_add_u32 v6, s25, v217
  v_cmp_gt_u32 vcc, s26, v6
  v_add_u32 v7, 64, v6
  v_cmp_gt_u32 s[34:35], s26, v7
  v_add_u32 v6, s24, v6
  v_lshlrev_b32 v6, 4, v6
  v_mov_b32 v200, 0
  v_mov_b32 v201, 0
  v_mov_b32 v202, 0
  v_mov_b32 v203, 0xffff0000
  s_mov_b64 exec, vcc
  ds_write_b128 v6, v[200:203] offset:5888
  s_mov_b64 exec, s[34:35]
  ds_write_b128 v6, v[200:203] offset:6912
  s_mov_b64 exec, -1
  s_waitcnt vmcnt(0) lgkmcnt(0)
  s_cmp_lg_u32 s21, 0
  s_cbranch_scc1 k2_havec2
  v_add_u32 v208, s32, v208
  v_add_u32 v209, s32, v209
  v_add_u32 v210, s32, v210
  v_add_u32 v211, s32, v211
  v_mov_b32 v212, v204
  v_mov_b32 v216, v205
  v_mov_b32 v2, v206
k2_havec2:
  s_mov_b64 exec, s[56:57]
  v_add_lshl_u32 v152, v152, v220, 4
  ds_write_b128 v152, v[88:91] offset:5888
  s_mov_b64 exec, s[58:59]
  v_add_lshl_u32 v153, v153, v221, 4
  ds_write_b128 v153, v[92:95] offset:5888
  s_mov_b64 exec, s[60:61]
  v_add_lshl_u32 v154, v154, v222, 4
  ds_write_b128 v154, v[96:99] offset:5888
  s_mov_b64 exec, s[62:63]
  v_add_lshl_u32 v155, v155, v223, 4
  ds_write_b128 v155, v[100:103] offset:5888
  s_mov_b64 exec, s[64:65]
  v_add_lshl_u32 v156, v156, v224, 4
  ds_write_b128 v156, v[104:107] offset:5888
  s_mov_b64 exec, s[66:67]
  v_add_lshl_u32 v157, v157, v225, 4
  ds_write_b128 v157, v[108:111] offset:5888
  s_mov_b64 exec, s[68:69]
  v_add_lshl_u32 v158, v158, v226, 4
  ds_write_b128 v158, v[112:115] offset:5888
  s_mov_b64 exec, s[70:71]
  v_add_lshl_u32 v159, v159, v227, 4
  ds_write_b128 v159, v[116:119] offset:5888
  s_cmp_eq_u64 s[72:73], 0
  s_cbranch_scc1 k2_pl8
  s_mov_b64 exec, s[72:73]
  v_add_lshl_u32 v160, v160, v228, 4
  ds_write_b128 v160, v[120:123] offset:5888
k2_pl8:
  s_cmp_eq_u64 s[74:75], 0
  s_cbranch_scc1 k2_pl9
  s_mov_b64 exec, s[74:75]
  v_add_lshl_u32 v161, v161, v229, 4
  ds_write_b128 v161, v[124:127] offset:5888
k2_pl9:
  s_cmp_eq_u64 s[76:77], 0
  s_cbranch_scc1 k2_pl10
  s_mov_b64 exec, s[76:77]
  v_add_lshl_u32 v162, v162, v230, 4
  ds_write_b128 v162, v[128:131] offset:5888
k2_pl10:
  s_cmp_eq_u64 s[78:79], 0
  s_cbranch_scc1 k2_pl11
  s_mov_b64 exec, s[78:79]
  v_add_lshl_u32 v163, v163, v231, 4
  ds_write_b128 v163, v[132:135] offset:5888
k2_pl11:
  s_cmp_eq_u64 s[80:81], 0
  s_cbranch_scc1 k2_pl12
  s_mov_b64 exec, s[80:81]
  v_add_lshl_u32 v252, v252, v232, 4
  ds_write_b128 v252, v[136:139] offset:5888
k2_pl12:
  s_cmp_eq_u64 s[82:83], 0
  s_cbranch_scc1 k2_pl13
  s_mov_b64 exec, s[82:83]
  v_add_lshl_u32 v253, v253, v233, 4
  ds_write_b128 v253, v[140:143] offset:5888
k2_pl13:
  s_cmp_eq_u64 s[84:85], 0
  s_cbranch_scc1 k2_pl14
  s_mov_b64 exec, s[84:85]
  v_add_lshl_u32 v254, v254, v234, 4
  ds_write_b128 v254, v[144:147] offset:5888
k2_pl14:
  s_cmp_eq_u64 s[86:87], 0
  s_cbranch_scc1 k2_pl15
  s_mov_b64 exec, s[86:87]
  v_add_lshl_u32 v255, v255, v235, 4
  ds_write_b128 v255, v[148:151] offset:5888
k2_pl15:
  s_mov_b64 exec, -1
  s_lshl_b32 s34, s24, 4
  s_add_u32 s34, s34, 5888
  v_add_u32 v238, s34, v2
  v_add_u32 v239, s34, v251
  s_lshl_b32 s18, s26, 1
  s_sub_u32 s19, s18, 32
  s_sub_u32 s28, s26, 64
  s_mov_b32 s31, 0
  s_mov_b32 s93, 0
  s_mov_b32 s48, 0
  s_mov_b32 s30, s49
  v_readlane_b32 s29, v215, s49
  s_mov_b32 m0, s32
  s_waitcnt lgkmcnt(0)
  s_barrier
  s_cmp_eq_u32 s26, 0
  s_cbranch_scc1 k2_roundend
  ds_read_u16 v218, v239
  ds_read_u16 v236, v239 offset:512
  ds_read_u16 v237, v239 offset:1024
  ds_read_b128 v[220:223], v238
  v_add_u32 v213, 512, v238
  v_add_u32 v214, 1536, v239
  s_cmp_ge_u32 s17, 4
  s_cbranch_scc0 k2_prio0
  s_setprio 1
k2_prio0:
  s_waitcnt lgkmcnt(3)
  v_lshlrev_b32 v218, 9, v218
  s_nop 1
  v_add_u32_dpp v196, v218, v212 quad_perm:[0,0,0,0] row_mask:0xf bank_mask:0xf
  v_add_u32_dpp v197, v218, v212 quad_perm:[1,1,1,1] row_mask:0xf bank_mask:0xf
  v_add_u32_dpp v198, v218, v212 quad_perm:[2,2,2,2] row_mask:0xf bank_mask:0xf
  v_add_u32_dpp v199, v218, v212 quad_perm:[3,3,3,3] row_mask:0xf bank_mask:0xf
  buffer_load_dwordx4 v196, s[4:7], s90 offen offset:0 lds
  buffer_load_dwordx4 v197, s[4:7], s91 offen offset:1024 lds
  buffer_load_dwordx4 v198, s[4:7], s92 offen offset:2048 lds
  buffer_load_dwordx4 v199, s[4:7], 0 offen offset:3072 lds
  s_add_u32 m0, s33, 4096
  s_waitcnt lgkmcnt(1)
  buffer_load_dwordx4 v196, s[4:7], s90 offen offset:128 lds
  buffer_load_dwordx4 v197, s[4:7], s91 offen offset:1152 lds
  buffer_load_dwordx4 v198, s[4:7], s92 offen offset:2176 lds
  buffer_load_dwordx4 v199, s[4:7], 0 offen offset:3200 lds
  v_lshlrev_b32 v236, 9, v236
  v_lshlrev_b32 v237, 9, v237
  s_add_u32 m0, s32, 8192
  v_add_u32_dpp v200, v236, v212 quad_perm:[0,0,0,0] row_mask:0xf bank_mask:0xf
  v_add_u32_dpp v201, v236, v212 quad_perm:[1,1,1,1] row_mask:0xf bank_mask:0xf
  v_add_u32_dpp v202, v236, v212 quad_perm:[2,2,2,2] row_mask:0xf bank_mask:0xf
  v_add_u32_dpp v203, v236, v212 quad_perm:[3,3,3,3] row_mask:0xf bank_mask:0xf
  buffer_load_dwordx4 v200, s[4:7], s90 offen offset:0 lds
  buffer_load_dwordx4 v201, s[4:7], s91 offen offset:1024 lds
  buffer_load_dwordx4 v202, s[4:7], s92 offen offset:2048 lds
  buffer_load_dwordx4 v203, s[4:7], 0 offen offset:3072 lds
  v_add_u32_dpp v204, v237, v212 quad_perm:[0,0,0,0] row_mask:0xf bank_mask:0xf
  v_add_u32_dpp v205, v237, v212 quad_perm:[1,1,1,1] row_mask:0xf bank_mask:0xf
  v_add_u32_dpp v206, v237, v212 quad_perm:[2,2,2,2] row_mask:0xf bank_mask:0xf
  v_add_u32_dpp v207, v237, v212 quad_perm:[3,3,3,3] row_mask:0xf bank_mask:0xf
  v_mov_b64 v[88:89], 0
  v_mov_b64 v[90:91], 0
  v_mov_b64 v[92:93], 0
  v_mov_b64 v[94:95], 0
  v_mov_b64 v[96:97], 0
  v_mov_b64 v[98:99], 0
  v_mov_b64 v[100:101], 0
  v_mov_b64 v[102:103], 0
  v_mov_b64 v[104:105], 0
  v_mov_b64 v[106:107], 0
  v_mov_b64 v[108:109], 0
  v_mov_b64 v[110:111], 0
  v_mov_b64 v[112:113], 0
  v_mov_b64 v[114:115], 0
  v_mov_b64 v[116:117], 0
  v_mov_b64 v[118:119], 0
  s_waitcnt lgkmcnt(0)
  v_lshlrev_b32 v224, 16, v220
  v_and_b32 v225, 0xffff0000, v220
  v_lshlrev_b32 v226, 16, v221
  v_and_b32 v227, 0xffff0000, v221
  v_and_or_b32 v236, v222, v248, v249
  v_perm_b32 v237, v223, v222, v250
  v_mul_f32 v228, v224, v236
  v_mul_f32 v229, v225, v236
  v_mul_f32 v230, v226, v236
  v_mul_f32 v231, v227, v236
  v_cvt_pk_bf16_f32 v232, v228, v229
  v_cvt_pk_bf16_f32 v233, v230, v231
  v_mul_f32 v228, v224, v237
  v_mul_f32 v229, v225, v237
  v_mul_f32 v230, v226, v237
  v_mul_f32 v231, v227, v237
  v_cvt_pk_bf16_f32 v234, v228, v229
  v_cvt_pk_bf16_f32 v235, v230, v231
  s_nop 1
  v_mfma_f32_16x16x32_bf16 v[224:227], v[232:235], v[240:243], 0
  v_mfma_f32_16x16x32_bf16 v[228:231], v[232:235], v[244:247], 0
  s_nop 7
  v_cvt_pk_bf16_f32 v152, v224, v225
  v_cvt_pk_bf16_f32 v153, v226, v227
  v_cvt_pk_bf16_f32 v154, v228, v229
  v_cvt_pk_bf16_f32 v155, v230, v231
k2_w0:
  s_add_u32 s48, s48, 32
  s_cmp_ge_u32 s48, s28
  s_cbranch_scc1 k2_w0_evt
k2_w0_top:
  s_cmp_le_u32 s29, s48
  s_cbranch_scc1 k2_w0_bnd
  s_waitcnt vmcnt(8)
  ds_read_b64_tr_b16 v[120:121], v208 offset:0
  ds_read_b64_tr_b16 v[122:123], v208 offset:2048
  ds_read_b64_tr_b16 v[124:125], v209 offset:0
  ds_read_b64_tr_b16 v[126:127], v209 offset:2048
  ds_read_b64_tr_b16 v[128:129], v210 offset:0
  ds_read_b64_tr_b16 v[130:131], v210 offset:2048
  ds_read_b64_tr_b16 v[132:133], v211 offset:0
  ds_read_b64_tr_b16 v[134:135], v211 offset:2048
  ds_read_b128 v[220:223], v213
  ds_read_u16 v218, v214
  s_waitcnt vmcnt(4)
  ds_read_b64_tr_b16 v[136:137], v208 offset:4096
  ds_read_b64_tr_b16 v[138:139], v208 offset:6144
  ds_read_b64_tr_b16 v[140:141], v209 offset:4096
  ds_read_b64_tr_b16 v[142:143], v209 offset:6144
  ds_read_b64_tr_b16 v[144:145], v210 offset:4096
  ds_read_b64_tr_b16 v[146:147], v210 offset:6144
  ds_read_b64_tr_b16 v[148:149], v211 offset:4096
  ds_read_b64_tr_b16 v[150:151], v211 offset:6144
  s_add_u32 m0, s33, 0
  s_cmp_ge_u32 s48, s18
  s_waitcnt lgkmcnt(8)
  s_cbranch_scc1 k2_w0n_skip0
  v_mfma_f32_16x16x32_bf16 v[88:91], v[152:155], v[120:123], v[88:91]
  buffer_load_dwordx4 v200, s[4:7], s90 offen offset:128 lds
  v_mfma_f32_16x16x32_bf16 v[92:95], v[152:155], v[124:127], v[92:95]
  v_mfma_f32_16x16x32_bf16 v[96:99], v[152:155], v[128:131], v[96:99]
  buffer_load_dwordx4 v201, s[4:7], s91 offen offset:1152 lds
  v_mfma_f32_16x16x32_bf16 v[100:103], v[152:155], v[132:135], v[100:103]
  s_waitcnt lgkmcnt(0)
  v_mfma_f32_16x16x32_bf16 v[104:107], v[152:155], v[136:139], v[104:107]
  buffer_load_dwordx4 v202, s[4:7], s92 offen offset:2176 lds
  v_mfma_f32_16x16x32_bf16 v[108:111], v[152:155], v[140:143], v[108:111]
  v_mfma_f32_16x16x32_bf16 v[112:115], v[152:155], v[144:147], v[112:115]
  buffer_load_dwordx4 v203, s[4:7], 0 offen offset:3200 lds
  v_mfma_f32_16x16x32_bf16 v[116:119], v[152:155], v[148:151], v[116:119]
k2_w0n_back0:
  s_branch k2_w0_done
k2_w0_bnd:
  s_waitcnt vmcnt(8)
  ds_read_b64_tr_b16 v[120:121], v208 offset:0
  ds_read_b64_tr_b16 v[122:123], v208 offset:2048
  ds_read_b64_tr_b16 v[124:125], v209 offset:0
  ds_read_b64_tr_b16 v[126:127], v209 offset:2048
  ds_read_b64_tr_b16 v[128:129], v210 offset:0
  ds_read_b64_tr_b16 v[130:131], v210 offset:2048
  ds_read_b64_tr_b16 v[132:133], v211 offset:0
  ds_read_b64_tr_b16 v[134:135], v211 offset:2048
  ds_read_b128 v[220:223], v213
  ds_read_u16 v218, v214
  s_sub_u32 s34, s48, s29
  s_lshl_b32 s34, s34, 6
  v_subrev_u32 v219, s34, v216
  ds_read_b128 v[160:163], v219
  s_waitcnt vmcnt(4)
  ds_read_b64_tr_b16 v[136:137], v208 offset:4096
  ds_read_b64_tr_b16 v[138:139], v208 offset:6144
  ds_read_b64_tr_b16 v[140:141], v209 offset:4096
  ds_read_b64_tr_b16 v[142:143], v209 offset:6144
  ds_read_b64_tr_b16 v[144:145], v210 offset:4096
  ds_read_b64_tr_b16 v[146:147], v210 offset:6144
  ds_read_b64_tr_b16 v[148:149], v211 offset:4096
  ds_read_b64_tr_b16 v[150:151], v211 offset:6144
  s_add_u32 m0, s33, 0
  s_cmp_ge_u32 s48, s18
  s_waitcnt lgkmcnt(8)
  v_and_b32 v156, v152, v160
  v_and_b32 v157, v153, v161
  v_and_b32 v158, v154, v162
  v_and_b32 v159, v155, v163
  v_xor_b32 v152, v152, v156
  v_xor_b32 v153, v153, v157
  v_xor_b32 v154, v154, v158
  v_xor_b32 v155, v155, v159
  s_cbranch_scc1 k2_w0b_skip0
  v_mfma_f32_16x16x32_bf16 v[88:91], v[156:159], v[120:123], v[88:91]
  buffer_load_dwordx4 v200, s[4:7], s90 offen offset:128 lds
  v_mfma_f32_16x16x32_bf16 v[92:95], v[156:159], v[124:127], v[92:95]
  v_mfma_f32_16x16x32_bf16 v[96:99], v[156:159], v[128:131], v[96:99]
  buffer_load_dwordx4 v201, s[4:7], s91 offen offset:1152 lds
  v_mfma_f32_16x16x32_bf16 v[100:103], v[156:159], v[132:135], v[100:103]
  s_waitcnt lgkmcnt(0)
  v_mfma_f32_16x16x32_bf16 v[104:107], v[156:159], v[136:139], v[104:107]
  buffer_load_dwordx4 v202, s[4:7], s92 offen offset:2176 lds
  v_mfma_f32_16x16x32_bf16 v[108:111], v[156:159], v[140:143], v[108:111]
  v_mfma_f32_16x16x32_bf16 v[112:115], v[156:159], v[144:147], v[112:115]
  buffer_load_dwordx4 v203, s[4:7], 0 offen offset:3200 lds
  v_mfma_f32_16x16x32_bf16 v[116:119], v[156:159], v[148:151], v[116:119]
k2_w0b_back0:
  s_set_gpr_idx_on s31, gpr_idx(DST)
  s_add_u32 s30, s30, 1
  v_fmac_f32 v8, v164, v88
  v_fmac_f32 v9, v168, v92
  v_fmac_f32 v10, v172, v96
  v_fmac_f32 v11, v176, v100
  v_fmac_f32 v8, v165, v89
  v_fmac_f32 v9, v169, v93
  v_fmac_f32 v10, v173, v97
  v_fmac_f32 v11, v177, v101
  v_fmac_f32 v8, v166, v90
  v_fmac_f32 v9, v170, v94
  v_fmac_f32 v10, v174, v98
  v_fmac_f32 v11, v178, v102
  v_fmac_f32 v8, v167, v91
  v_fmac_f32 v9, v171, v95
  v_fmac_f32 v10, v175, v99
  v_fmac_f32 v11, v179, v103
  v_fmac_f32 v12, v180, v104
  v_fmac_f32 v13, v184, v108
  v_fmac_f32 v14, v188, v112
  v_fmac_f32 v15, v192, v116
  v_fmac_f32 v12, v181, v105
  v_fmac_f32 v13, v185, v109
  v_fmac_f32 v14, v189, v113
  v_fmac_f32 v15, v193, v117
  v_fmac_f32 v12, v182, v106
  v_fmac_f32 v13, v186, v110
  v_fmac_f32 v14, v190, v114
  v_fmac_f32 v15, v194, v118
  v_fmac_f32 v12, v183, v107
  v_fmac_f32 v13, v187, v111
  v_fmac_f32 v14, v191, v115
  v_fmac_f32 v15, v195, v119
  s_set_gpr_idx_off
  v_readlane_b32 s29, v215, s30
  s_add_u32 s31, s31, 16
  s_add_u32 s29, s29, s93
k2_w0_more:
  s_cmp_le_u32 s29, s48
  s_cbranch_scc1 k2_w0_again
  v_mfma_f32_16x16x32_bf16 v[88:91], v[152:155], v[120:123], 0
  v_mfma_f32_16x16x32_bf16 v[92:95], v[152:155], v[124:127], 0
  v_mfma_f32_16x16x32_bf16 v[96:99], v[152:155], v[128:131], 0
  v_mfma_f32_16x16x32_bf16 v[100:103], v[152:155], v[132:135], 0
  v_mfma_f32_16x16x32_bf16 v[104:107], v[152:155], v[136:139], 0
  v_mfma_f32_16x16x32_bf16 v[108:111], v[152:155], v[140:143], 0
  v_mfma_f32_16x16x32_bf16 v[112:115], v[152:155], v[144:147], 0
  v_mfma_f32_16x16x32_bf16 v[116:119], v[152:155], v[148:151], 0
k2_w0_done:
  s_add_u32 m0, s32, 4096
  s_cmp_ge_u32 s48, s19
  s_cbranch_scc1 k2_w0_nextskip
  v_lshlrev_b32 v224, 16, v220
  v_and_b32 v225, 0xffff0000, v220
  buffer_load_dwordx4 v204, s[4:7], s90 offen offset:0 lds
  v_lshlrev_b32 v226, 16, v221
  v_and_b32 v227, 0xffff0000, v221
  v_and_or_b32 v236, v222, v248, v249
  v_perm_b32 v237, v223, v222, v250
  buffer_load_dwordx4 v205, s[4:7], s91 offen offset:1024 lds
  v_mul_f32 v228, v224, v236
  v_mul_f32 v229, v225, v236
  v_mul_f32 v230, v226, v236
  v_mul_f32 v231, v227, v236
  buffer_load_dwordx4 v206, s[4:7], s92 offen offset:2048 lds
  v_cvt_pk_bf16_f32 v232, v228, v229
  v_cvt_pk_bf16_f32 v233, v230, v231
  v_mul_f32 v228, v224, v237
  v_mul_f32 v229, v225, v237
  buffer_load_dwordx4 v207, s[4:7], 0 offen offset:3072 lds
  v_mul_f32 v230, v226, v237
  v_mul_f32 v231, v227, v237
  v_cvt_pk_bf16_f32 v234, v228, v229
  v_cvt_pk_bf16_f32 v235, v230, v231
  v_lshlrev_b32 v218, 9, v218
  v_add_u32 v213, 512, v213
  v_mfma_f32_16x16x32_bf16 v[224:227], v[232:235], v[240:243], 0
  v_mfma_f32_16x16x32_bf16 v[228:231], v[232:235], v[244:247], 0
  v_add_u32 v214, 512, v214
  v_add_u32_dpp v196, v218, v212 quad_perm:[0,0,0,0] row_mask:0xf bank_mask:0xf
  v_add_u32_dpp v197, v218, v212 quad_perm:[1,1,1,1] row_mask:0xf bank_mask:0xf
  v_add_u32_dpp v198, v218, v212 quad_perm:[2,2,2,2] row_mask:0xf bank_mask:0xf
  v_add_u32_dpp v199, v218, v212 quad_perm:[3,3,3,3] row_mask:0xf bank_mask:0xf
k2_w0_fin:
  s_cmp_ge_u32 s48, s18
  s_cbranch_scc1 k2_streamdone
  v_cvt_pk_bf16_f32 v152, v224, v225
  v_cvt_pk_bf16_f32 v153, v226, v227
  v_cvt_pk_bf16_f32 v154, v228, v229
  v_cvt_pk_bf16_f32 v155, v230, v231
k2_w1:
  s_add_u32 s48, s48, 32
  s_cmp_ge_u32 s48, s28
  s_cbranch_scc1 k2_w1_evt
k2_w1_top:
  s_cmp_le_u32 s29, s48
  s_cbranch_scc1 k2_w1_bnd
  s_waitcnt vmcnt(8)
  ds_read_b64_tr_b16 v[120:121], v208 offset:8192
  ds_read_b64_tr_b16 v[122:123], v208 offset:10240
  ds_read_b64_tr_b16 v[124:125], v209 offset:8192
  ds_read_b64_tr_b16 v[126:127], v209 offset:10240
  ds_read_b64_tr_b16 v[128:129], v210 offset:8192
  ds_read_b64_tr_b16 v[130:131], v210 offset:10240
  ds_read_b64_tr_b16 v[132:133], v211 offset:8192
  ds_read_b64_tr_b16 v[134:135], v211 offset:10240
  ds_read_b128 v[220:223], v213
  ds_read_u16 v218, v214
  s_waitcnt vmcnt(4)
  ds_read_b64_tr_b16 v[136:137], v208 offset:0
  ds_read_b64_tr_b16 v[138:139], v208 offset:2048
  ds_read_b64_tr_b16 v[140:141], v209 offset:0
  ds_read_b64_tr_b16 v[142:143], v209 offset:2048
  ds_read_b64_tr_b16 v[144:145], v210 offset:0
  ds_read_b64_tr_b16 v[146:147], v210 offset:2048
  ds_read_b64_tr_b16 v[148:149], v211 offset:0
  ds_read_b64_tr_b16 v[150:151], v211 offset:2048
  s_add_u32 m0, s33, 8192
  s_cmp_ge_u32 s48, s18
  s_waitcnt lgkmcnt(8)
  s_cbranch_scc1 k2_w1n_skip0
  v_mfma_f32_16x16x32_bf16 v[88:91], v[152:155], v[120:123], v[88:91]
  buffer_load_dwordx4 v204, s[4:7], s90 offen offset:128 lds
  v_mfma_f32_16x16x32_bf16 v[92:95], v[152:155], v[124:127], v[92:95]
  v_mfma_f32_16x16x32_bf16 v[96:99], v[152:155], v[128:131], v[96:99]
  buffer_load_dwordx4 v205, s[4:7], s91 offen offset:1152 lds
  v_mfma_f32_16x16x32_bf16 v[100:103], v[152:155], v[132:135], v[100:103]
  s_waitcnt lgkmcnt(0)
  v_mfma_f32_16x16x32_bf16 v[104:107], v[152:155], v[136:139], v[104:107]
  buffer_load_dwordx4 v206, s[4:7], s92 offen offset:2176 lds
  v_mfma_f32_16x16x32_bf16 v[108:111], v[152:155], v[140:143], v[108:111]
  v_mfma_f32_16x16x32_bf16 v[112:115], v[152:155], v[144:147], v[112:115]
  buffer_load_dwordx4 v207, s[4:7], 0 offen offset:3200 lds
  v_mfma_f32_16x16x32_bf16 v[116:119], v[152:155], v[148:151], v[116:119]
k2_w1n_back0:
  s_branch k2_w1_done
k2_w1_bnd:
  s_waitcnt vmcnt(8)
  ds_read_b64_tr_b16 v[120:121], v208 offset:8192
  ds_read_b64_tr_b16 v[122:123], v208 offset:10240
  ds_read_b64_tr_b16 v[124:125], v209 offset:8192
  ds_read_b64_tr_b16 v[126:127], v209 offset:10240
  ds_read_b64_tr_b16 v[128:129], v210 offset:8192
  ds_read_b64_tr_b16 v[130:131], v210 offset:10240
  ds_read_b64_tr_b16 v[132:133], v211 offset:8192
  ds_read_b64_tr_b16 v[134:135], v211 offset:10240
  ds_read_b128 v[220:223], v213
  ds_read_u16 v218, v214
  s_sub_u32 s34, s48, s29
  s_lshl_b32 s34, s34, 6
  v_subrev_u32 v219, s34, v216
  ds_read_b128 v[160:163], v219
  s_waitcnt vmcnt(4)
  ds_read_b64_tr_b16 v[136:137], v208 offset:0
  ds_read_b64_tr_b16 v[138:139], v208 offset:2048
  ds_read_b64_tr_b16 v[140:141], v209 offset:0
  ds_read_b64_tr_b16 v[142:143], v209 offset:2048
  ds_read_b64_tr_b16 v[144:145], v210 offset:0
  ds_read_b64_tr_b16 v[146:147], v210 offset:2048
  ds_read_b64_tr_b16 v[148:149], v211 offset:0
  ds_read_b64_tr_b16 v[150:151], v211 offset:2048
  s_add_u32 m0, s33, 8192
  s_cmp_ge_u32 s48, s18
  s_waitcnt lgkmcnt(8)
  v_and_b32 v156, v152, v160
  v_and_b32 v157, v153, v161
  v_and_b32 v158, v154, v162
  v_and_b32 v159, v155, v163
  v_xor_b32 v152, v152, v156
  v_xor_b32 v153, v153, v157
  v_xor_b32 v154, v154, v158
  v_xor_b32 v155, v155, v159
  s_cbranch_scc1 k2_w1b_skip0
  v_mfma_f32_16x16x32_bf16 v[88:91], v[156:159], v[120:123], v[88:91]
  buffer_load_dwordx4 v204, s[4:7], s90 offen offset:128 lds
  v_mfma_f32_16x16x32_bf16 v[92:95], v[156:159], v[124:127], v[92:95]
  v_mfma_f32_16x16x32_bf16 v[96:99], v[156:159], v[128:131], v[96:99]
  buffer_load_dwordx4 v205, s[4:7], s91 offen offset:1152 lds
  v_mfma_f32_16x16x32_bf16 v[100:103], v[156:159], v[132:135], v[100:103]
  s_waitcnt lgkmcnt(0)
  v_mfma_f32_16x16x32_bf16 v[104:107], v[156:159], v[136:139], v[104:107]
  buffer_load_dwordx4 v206, s[4:7], s92 offen offset:2176 lds
  v_mfma_f32_16x16x32_bf16 v[108:111], v[156:159], v[140:143], v[108:111]
  v_mfma_f32_16x16x32_bf16 v[112:115], v[156:159], v[144:147], v[112:115]
  buffer_load_dwordx4 v207, s[4:7], 0 offen offset:3200 lds
  v_mfma_f32_16x16x32_bf16 v[116:119], v[156:159], v[148:151], v[116:119]
k2_w1b_back0:
  s_set_gpr_idx_on s31, gpr_idx(DST)
  s_add_u32 s30, s30, 1
  v_fmac_f32 v8, v164, v88
  v_fmac_f32 v9, v168, v92
  v_fmac_f32 v10, v172, v96
  v_fmac_f32 v11, v176, v100
  v_fmac_f32 v8, v165, v89
  v_fmac_f32 v9, v169, v93
  v_fmac_f32 v10, v173, v97
  v_fmac_f32 v11, v177, v101
  v_fmac_f32 v8, v166, v90
  v_fmac_f32 v9, v170, v94
  v_fmac_f32 v10, v174, v98
  v_fmac_f32 v11, v178, v102
  v_fmac_f32 v8, v167, v91
  v_fmac_f32 v9, v171, v95
  v_fmac_f32 v10, v175, v99
  v_fmac_f32 v11, v179, v103
  v_fmac_f32 v12, v180, v104
  v_fmac_f32 v13, v184, v108
  v_fmac_f32 v14, v188, v112
  v_fmac_f32 v15, v192, v116
  v_fmac_f32 v12, v181, v105
  v_fmac_f32 v13, v185, v109
  v_fmac_f32 v14, v189, v113
  v_fmac_f32 v15, v193, v117
  v_fmac_f32 v12, v182, v106
  v_fmac_f32 v13, v186, v110
  v_fmac_f32 v14, v190, v114
  v_fmac_f32 v15, v194, v118
  v_fmac_f32 v12, v183, v107
  v_fmac_f32 v13, v187, v111
  v_fmac_f32 v14, v191, v115
  v_fmac_f32 v15, v195, v119
  s_set_gpr_idx_off
  v_readlane_b32 s29, v215, s30
  s_add_u32 s31, s31, 16
  s_add_u32 s29, s29, s93
k2_w1_more:
  s_cmp_le_u32 s29, s48
  s_cbranch_scc1 k2_w1_again
  v_mfma_f32_16x16x32_bf16 v[88:91], v[152:155], v[120:123], 0
  v_mfma_f32_16x16x32_bf16 v[92:95], v[152:155], v[124:127], 0
  v_mfma_f32_16x16x32_bf16 v[96:99], v[152:155], v[128:131], 0
  v_mfma_f32_16x16x32_bf16 v[100:103], v[152:155], v[132:135], 0
  v_mfma_f32_16x16x32_bf16 v[104:107], v[152:155], v[136:139], 0
  v_mfma_f32_16x16x32_bf16 v[108:111], v[152:155], v[140:143], 0
  v_mfma_f32_16x16x32_bf16 v[112:115], v[152:155], v[144:147], 0
  v_mfma_f32_16x16x32_bf16 v[116:119], v[152:155], v[148:151], 0
k2_w1_done:
  s_add_u32 m0, s32, 0
  s_cmp_ge_u32 s48, s19
  s_cbranch_scc1 k2_w1_nextskip
  v_lshlrev_b32 v224, 16, v220
  v_and_b32 v225, 0xffff0000, v220
  buffer_load_dwordx4 v196, s[4:7], s90 offen offset:0 lds
  v_lshlrev_b32 v226, 16, v221
  v_and_b32 v227, 0xffff0000, v221
  v_and_or_b32 v236, v222, v248, v249
  v_perm_b32 v237, v223, v222, v250
  buffer_load_dwordx4 v197, s[4:7], s91 offen offset:1024 lds
  v_mul_f32 v228, v224, v236
  v_mul_f32 v229, v225, v236
  v_mul_f32 v230, v226, v236
  v_mul_f32 v231, v227, v236
  buffer_load_dwordx4 v198, s[4:7], s92 offen offset:2048 lds
  v_cvt_pk_bf16_f32 v232, v228, v229
  v_cvt_pk_bf16_f32 v233, v230, v231
  v_mul_f32 v228, v224, v237
  v_mul_f32 v229, v225, v237
  buffer_load_dwordx4 v199, s[4:7], 0 offen offset:3072 lds
  v_mul_f32 v230, v226, v237
  v_mul_f32 v231, v227, v237
  v_cvt_pk_bf16_f32 v234, v228, v229
  v_cvt_pk_bf16_f32 v235, v230, v231
  v_lshlrev_b32 v218, 9, v218
  v_add_u32 v213, 512, v213
  v_mfma_f32_16x16x32_bf16 v[224:227], v[232:235], v[240:243], 0
  v_mfma_f32_16x16x32_bf16 v[228:231], v[232:235], v[244:247], 0
  v_add_u32 v214, 512, v214
  v_add_u32_dpp v200, v218, v212 quad_perm:[0,0,0,0] row_mask:0xf bank_mask:0xf
  v_add_u32_dpp v201, v218, v212 quad_perm:[1,1,1,1] row_mask:0xf bank_mask:0xf
  v_add_u32_dpp v202, v218, v212 quad_perm:[2,2,2,2] row_mask:0xf bank_mask:0xf
  v_add_u32_dpp v203, v218, v212 quad_perm:[3,3,3,3] row_mask:0xf bank_mask:0xf
k2_w1_fin:
  s_cmp_ge_u32 s48, s18
  s_cbranch_scc1 k2_streamdone
  v_cvt_pk_bf16_f32 v152, v224, v225
  v_cvt_pk_bf16_f32 v153, v226, v227
  v_cvt_pk_bf16_f32 v154, v228, v229
  v_cvt_pk_bf16_f32 v155, v230, v231
k2_w2:
  s_add_u32 s48, s48, 32
  s_cmp_ge_u32 s48, s28
  s_cbranch_scc1 k2_w2_evt
k2_w2_top:
  s_cmp_le_u32 s29, s48
  s_cbranch_scc1 k2_w2_bnd
  s_waitcnt vmcnt(8)
  ds_read_b64_tr_b16 v[120:121], v208 offset:4096
  ds_read_b64_tr_b16 v[122:123], v208 offset:6144
  ds_read_b64_tr_b16 v[124:125], v209 offset:4096
  ds_read_b64_tr_b16 v[126:127], v209 offset:6144
  ds_read_b64_tr_b16 v[128:129], v210 offset:4096
  ds_read_b64_tr_b16 v[130:131], v210 offset:6144
  ds_read_b64_tr_b16 v[132:133], v211 offset:4096
  ds_read_b64_tr_b16 v[134:135], v211 offset:6144
  ds_read_b128 v[220:223], v213
  ds_read_u16 v218, v214
  s_waitcnt vmcnt(4)
  ds_read_b64_tr_b16 v[136:137], v208 offset:8192
  ds_read_b64_tr_b16 v[138:139], v208 offset:10240
  ds_read_b64_tr_b16 v[140:141], v209 offset:8192
  ds_read_b64_tr_b16 v[142:143], v209 offset:10240
  ds_read_b64_tr_b16 v[144:145], v210 offset:8192
  ds_read_b64_tr_b16 v[146:147], v210 offset:10240
  ds_read_b64_tr_b16 v[148:149], v211 offset:8192
  ds_read_b64_tr_b16 v[150:151], v211 offset:10240
  s_add_u32 m0, s33, 4096
  s_cmp_ge_u32 s48, s18
  s_waitcnt lgkmcnt(8)
  s_cbranch_scc1 k2_w2n_skip0
  v_mfma_f32_16x16x32_bf16 v[88:91], v[152:155], v[120:123], v[88:91]
  buffer_load_dwordx4 v196, s[4:7], s90 offen offset:128 lds
  v_mfma_f32_16x16x32_bf16 v[92:95], v[152:155], v[124:127], v[92:95]
  v_mfma_f32_16x16x32_bf16 v[96:99], v[152:155], v[128:131], v[96:99]
  buffer_load_dwordx4 v197, s[4:7], s91 offen offset:1152 lds
  v_mfma_f32_16x16x32_bf16 v[100:103], v[152:155], v[132:135], v[100:103]
  s_waitcnt lgkmcnt(0)
  v_mfma_f32_16x16x32_bf16 v[104:107], v[152:155], v[136:139], v[104:107]
  buffer_load_dwordx4 v198, s[4:7], s92 offen offset:2176 lds
  v_mfma_f32_16x16x32_bf16 v[108:111], v[152:155], v[140:143], v[108:111]
  v_mfma_f32_16x16x32_bf16 v[112:115], v[152:155], v[144:147], v[112:115]
  buffer_load_dwordx4 v199, s[4:7], 0 offen offset:3200 lds
  v_mfma_f32_16x16x32_bf16 v[116:119], v[152:155], v[148:151], v[116:119]
k2_w2n_back0:
  s_branch k2_w2_done
k2_w2_bnd:
  s_waitcnt vmcnt(8)
  ds_read_b64_tr_b16 v[120:121], v208 offset:4096
  ds_read_b64_tr_b16 v[122:123], v208 offset:6144
  ds_read_b64_tr_b16 v[124:125], v209 offset:4096
  ds_read_b64_tr_b16 v[126:127], v209 offset:6144
  ds_read_b64_tr_b16 v[128:129], v210 offset:4096
  ds_read_b64_tr_b16 v[130:131], v210 offset:6144
  ds_read_b64_tr_b16 v[132:133], v211 offset:4096
  ds_read_b64_tr_b16 v[134:135], v211 offset:6144
  ds_read_b128 v[220:223], v213
  ds_read_u16 v218, v214
  s_sub_u32 s34, s48, s29
  s_lshl_b32 s34, s34, 6
  v_subrev_u32 v219, s34, v216
  ds_read_b128 v[160:163], v219
  s_waitcnt vmcnt(4)
  ds_read_b64_tr_b16 v[136:137], v208 offset:8192
  ds_read_b64_tr_b16 v[138:139], v208 offset:10240
  ds_read_b64_tr_b16 v[140:141], v209 offset:8192
  ds_read_b64_tr_b16 v[142:143], v209 offset:10240
  ds_read_b64_tr_b16 v[144:145], v210 offset:8192
  ds_read_b64_tr_b16 v[146:147], v210 offset:10240
  ds_read_b64_tr_b16 v[148:149], v211 offset:8192
  ds_read_b64_tr_b16 v[150:151], v211 offset:10240
  s_add_u32 m0, s33, 4096
  s_cmp_ge_u32 s48, s18
  s_waitcnt lgkmcnt(8)
  v_and_b32 v156, v152, v160
  v_and_b32 v157, v153, v161
  v_and_b32 v158, v154, v162
  v_and_b32 v159, v155, v163
  v_xor_b32 v152, v152, v156
  v_xor_b32 v153, v153, v157
  v_xor_b32 v154, v154, v158
  v_xor_b32 v155, v155, v159
  s_cbranch_scc1 k2_w2b_skip0
  v_mfma_f32_16x16x32_bf16 v[88:91], v[156:159], v[120:123], v[88:91]
  buffer_load_dwordx4 v196, s[4:7], s90 offen offset:128 lds
  v_mfma_f32_16x16x32_bf16 v[92:95], v[156:159], v[124:127], v[92:95]
  v_mfma_f32_16x16x32_bf16 v[96:99], v[156:159], v[128:131], v[96:99]
  buffer_load_dwordx4 v197, s[4:7], s91 offen offset:1152 lds
  v_mfma_f32_16x16x32_bf16 v[100:103], v[156:159], v[132:135], v[100:103]
  s_waitcnt lgkmcnt(0)
  v_mfma_f32_16x16x32_bf16 v[104:107], v[156:159], v[136:139], v[104:107]
  buffer_load_dwordx4 v198, s[4:7], s92 offen offset:2176 lds
  v_mfma_f32_16x16x32_bf16 v[108:111], v[156:159], v[140:143], v[108:111]
  v_mfma_f32_16x16x32_bf16 v[112:115], v[156:159], v[144:147], v[112:115]
  buffer_load_dwordx4 v199, s[4:7], 0 offen offset:3200 lds
  v_mfma_f32_16x16x32_bf16 v[116:119], v[156:159], v[148:151], v[116:119]
k2_w2b_back0:
  s_set_gpr_idx_on s31, gpr_idx(DST)
  s_add_u32 s30, s30, 1
  v_fmac_f32 v8, v164, v88
  v_fmac_f32 v9, v168, v92
  v_fmac_f32 v10, v172, v96
  v_fmac_f32 v11, v176, v100
  v_fmac_f32 v8, v165, v89
  v_fmac_f32 v9, v169, v93
  v_fmac_f32 v10, v173, v97
  v_fmac_f32 v11, v177, v101
  v_fmac_f32 v8, v166, v90
  v_fmac_f32 v9, v170, v94
  v_fmac_f32 v10, v174, v98
  v_fmac_f32 v11, v178, v102
  v_fmac_f32 v8, v167, v91
  v_fmac_f32 v9, v171, v95
  v_fmac_f32 v10, v175, v99
  v_fmac_f32 v11, v179, v103
  v_fmac_f32 v12, v180, v104
  v_fmac_f32 v13, v184, v108
  v_fmac_f32 v14, v188, v112
  v_fmac_f32 v15, v192, v116
  v_fmac_f32 v12, v181, v105
  v_fmac_f32 v13, v185, v109
  v_fmac_f32 v14, v189, v113
  v_fmac_f32 v15, v193, v117
  v_fmac_f32 v12, v182, v106
  v_fmac_f32 v13, v186, v110
  v_fmac_f32 v14, v190, v114
  v_fmac_f32 v15, v194, v118
  v_fmac_f32 v12, v183, v107
  v_fmac_f32 v13, v187, v111
  v_fmac_f32 v14, v191, v115
  v_fmac_f32 v15, v195, v119
  s_set_gpr_idx_off
  v_readlane_b32 s29, v215, s30
  s_add_u32 s31, s31, 16
  s_add_u32 s29, s29, s93
k2_w2_more:
  s_cmp_le_u32 s29, s48
  s_cbranch_scc1 k2_w2_again
  v_mfma_f32_16x16x32_bf16 v[88:91], v[152:155], v[120:123], 0
  v_mfma_f32_16x16x32_bf16 v[92:95], v[152:155], v[124:127], 0
  v_mfma_f32_16x16x32_bf16 v[96:99], v[152:155], v[128:131], 0
  v_mfma_f32_16x16x32_bf16 v[100:103], v[152:155], v[132:135], 0
  v_mfma_f32_16x16x32_bf16 v[104:107], v[152:155], v[136:139], 0
  v_mfma_f32_16x16x32_bf16 v[108:111], v[152:155], v[140:143], 0
  v_mfma_f32_16x16x32_bf16 v[112:115], v[152:155], v[144:147], 0
  v_mfma_f32_16x16x32_bf16 v[116:119], v[152:155], v[148:151], 0
k2_w2_done:
  s_add_u32 m0, s32, 8192
  s_cmp_ge_u32 s48, s19
  s_cbranch_scc1 k2_w2_nextskip
  v_lshlrev_b32 v224, 16, v220
  v_and_b32 v225, 0xffff0000, v220
  buffer_load_dwordx4 v200, s[4:7], s90 offen offset:0 lds
  v_lshlrev_b32 v226, 16, v221
  v_and_b32 v227, 0xffff0000, v221
  v_and_or_b32 v236, v222, v248, v249
  v_perm_b32 v237, v223, v222, v250
  buffer_load_dwordx4 v201, s[4:7], s91 offen offset:1024 lds
  v_mul_f32 v228, v224, v236
  v_mul_f32 v229, v225, v236
  v_mul_f32 v230, v226, v236
  v_mul_f32 v231, v227, v236
  buffer_load_dwordx4 v202, s[4:7], s92 offen offset:2048 lds
  v_cvt_pk_bf16_f32 v232, v228, v229
  v_cvt_pk_bf16_f32 v233, v230, v231
  v_mul_f32 v228, v224, v237
  v_mul_f32 v229, v225, v237
  buffer_load_dwordx4 v203, s[4:7], 0 offen offset:3072 lds
  v_mul_f32 v230, v226, v237
  v_mul_f32 v231, v227, v237
  v_cvt_pk_bf16_f32 v234, v228, v229
  v_cvt_pk_bf16_f32 v235, v230, v231
  v_lshlrev_b32 v218, 9, v218
  v_add_u32 v213, 512, v213
  v_mfma_f32_16x16x32_bf16 v[224:227], v[232:235], v[240:243], 0
  v_mfma_f32_16x16x32_bf16 v[228:231], v[232:235], v[244:247], 0
  v_add_u32 v214, 512, v214
  v_add_u32_dpp v204, v218, v212 quad_perm:[0,0,0,0] row_mask:0xf bank_mask:0xf
  v_add_u32_dpp v205, v218, v212 quad_perm:[1,1,1,1] row_mask:0xf bank_mask:0xf
  v_add_u32_dpp v206, v218, v212 quad_perm:[2,2,2,2] row_mask:0xf bank_mask:0xf
  v_add_u32_dpp v207, v218, v212 quad_perm:[3,3,3,3] row_mask:0xf bank_mask:0xf
k2_w2_fin:
  s_cmp_ge_u32 s48, s18
  s_cbranch_scc1 k2_streamdone
  v_cvt_pk_bf16_f32 v152, v224, v225
  v_cvt_pk_bf16_f32 v153, v226, v227
  v_cvt_pk_bf16_f32 v154, v228, v229
  v_cvt_pk_bf16_f32 v155, v230, v231
  s_branch k2_w0
k2_w0_again:
  s_sub_u32 s34, s48, s29
  s_lshl_b32 s34, s34, 6
  v_subrev_u32 v219, s34, v216
  ds_read_b128 v[160:163], v219
  s_waitcnt lgkmcnt(0)
  v_and_b32 v156, v152, v160
  v_and_b32 v157, v153, v161
  v_and_b32 v158, v154, v162
  v_and_b32 v159, v155, v163
  v_xor_b32 v152, v152, v156
  v_xor_b32 v153, v153, v157
  v_xor_b32 v154, v154, v158
  v_xor_b32 v155, v155, v159
  s_nop 0
  v_mfma_f32_16x16x32_bf16 v[88:91], v[156:159], v[120:123], 0
  v_mfma_f32_16x16x32_bf16 v[92:95], v[156:159], v[124:127], 0
  v_mfma_f32_16x16x32_bf16 v[96:99], v[156:159], v[128:131], 0
  v_mfma_f32_16x16x32_bf16 v[100:103], v[156:159], v[132:135], 0
  v_mfma_f32_16x16x32_bf16 v[104:107], v[156:159], v[136:139], 0
  v_mfma_f32_16x16x32_bf16 v[108:111], v[156:159], v[140:143], 0
  v_mfma_f32_16x16x32_bf16 v[112:115], v[156:159], v[144:147], 0
  v_mfma_f32_16x16x32_bf16 v[116:119], v[156:159], v[148:151], 0
  s_set_gpr_idx_on s31, gpr_idx(DST)
  s_add_u32 s30, s30, 1
  v_fmac_f32 v8, v164, v88
  v_fmac_f32 v9, v168, v92
  v_fmac_f32 v10, v172, v96
  v_fmac_f32 v11, v176, v100
  v_fmac_f32 v8, v165, v89
  v_fmac_f32 v9, v169, v93
  v_fmac_f32 v10, v173, v97
  v_fmac_f32 v11, v177, v101
  v_fmac_f32 v8, v166, v90
  v_fmac_f32 v9, v170, v94
  v_fmac_f32 v10, v174, v98
  v_fmac_f32 v11, v178, v102
  v_fmac_f32 v8, v167, v91
  v_fmac_f32 v9, v171, v95
  v_fmac_f32 v10, v175, v99
  v_fmac_f32 v11, v179, v103
  v_fmac_f32 v12, v180, v104
  v_fmac_f32 v13, v184, v108
  v_fmac_f32 v14, v188, v112
  v_fmac_f32 v15, v192, v116
  v_fmac_f32 v12, v181, v105
  v_fmac_f32 v13, v185, v109
  v_fmac_f32 v14, v189, v113
  v_fmac_f32 v15, v193, v117
  v_fmac_f32 v12, v182, v106
  v_fmac_f32 v13, v186, v110
  v_fmac_f32 v14, v190, v114
  v_fmac_f32 v15, v194, v118
  v_fmac_f32 v12, v183, v107
  v_fmac_f32 v13, v187, v111
  v_fmac_f32 v14, v191, v115
  v_fmac_f32 v15, v195, v119
  s_set_gpr_idx_off
  v_readlane_b32 s29, v215, s30
  s_add_u32 s31, s31, 16
  s_add_u32 s29, s29, s93
  s_branch k2_w0_more
k2_w0_evt:
  s_cmp_eq_u32 s48, s26
  s_cbranch_scc1 k2_w0_e2
  s_cmp_eq_u32 s48, s18
  s_cbranch_scc1 k2_w0_e4
  s_cmp_gt_u32 s48, s26
  s_cbranch_scc1 k2_w0_e3
  v_mov_b32 v214, v239
  v_add_u32 v212, 256, v212
  s_mov_b32 s28, s26
  s_branch k2_w0_top
k2_w0_e2:
  v_mov_b32 v213, v238
  s_add_u32 s28, s26, 32
  s_branch k2_w0_top
k2_w0_e3:
  v_lshlrev_b32 v219, 4, v217
  v_add_u32 v219, 154368, v219
  ds_read_b128 v[164:167], v219 offset:0
  ds_read_b128 v[168:171], v219 offset:1024
  ds_read_b128 v[172:175], v219 offset:2048
  ds_read_b128 v[176:179], v219 offset:3072
  ds_read_b128 v[180:183], v219 offset:4096
  ds_read_b128 v[184:187], v219 offset:5120
  ds_read_b128 v[188:191], v219 offset:6144
  ds_read_b128 v[192:195], v219 offset:7168
  v_mov_b64 v[88:89], 0
  v_mov_b64 v[90:91], 0
  v_mov_b64 v[92:93], 0
  v_mov_b64 v[94:95], 0
  v_mov_b64 v[96:97], 0
  v_mov_b64 v[98:99], 0
  v_mov_b64 v[100:101], 0
  v_mov_b64 v[102:103], 0
  v_mov_b64 v[104:105], 0
  v_mov_b64 v[106:107], 0
  v_mov_b64 v[108:109], 0
  v_mov_b64 v[110:111], 0
  v_mov_b64 v[112:113], 0
  v_mov_b64 v[114:115], 0
  v_mov_b64 v[116:117], 0
  v_mov_b64 v[118:119], 0
  s_mov_b32 s30, s49
  s_mov_b32 s31, 8
  s_mov_b32 s93, s26
  s_mov_b32 s28, s18
  v_readlane_b32 s29, v215, s49
  s_setprio 1
  s_cmp_ge_u32 s17, 4
  s_cbranch_scc0 k2_w0_pr
  s_setprio 0
k2_w0_pr:
  s_add_u32 s29, s29, s26
  s_branch k2_w0_top
k2_w0_e4:
  s_waitcnt vmcnt(0)
  s_mov_b32 s28, -1
  s_branch k2_w0_top
k2_w0_nextskip:
  v_lshlrev_b32 v224, 16, v220
  v_and_b32 v225, 0xffff0000, v220
  v_lshlrev_b32 v226, 16, v221
  v_and_b32 v227, 0xffff0000, v221
  v_and_or_b32 v236, v222, v248, v249
  v_perm_b32 v237, v223, v222, v250
  v_mul_f32 v228, v224, v236
  v_mul_f32 v229, v225, v236
  v_mul_f32 v230, v226, v236
  v_mul_f32 v231, v227, v236
  v_cvt_pk_bf16_f32 v232, v228, v229
  v_cvt_pk_bf16_f32 v233, v230, v231
  v_mul_f32 v228, v224, v237
  v_mul_f32 v229, v225, v237
  v_mul_f32 v230, v226, v237
  v_mul_f32 v231, v227, v237
  v_cvt_pk_bf16_f32 v234, v228, v229
  v_cvt_pk_bf16_f32 v235, v230, v231
  v_lshlrev_b32 v218, 9, v218
  v_add_u32 v213, 512, v213
  v_mfma_f32_16x16x32_bf16 v[224:227], v[232:235], v[240:243], 0
  v_mfma_f32_16x16x32_bf16 v[228:231], v[232:235], v[244:247], 0
  v_add_u32 v214, 512, v214
  v_add_u32_dpp v196, v218, v212 quad_perm:[0,0,0,0] row_mask:0xf bank_mask:0xf
  v_add_u32_dpp v197, v218, v212 quad_perm:[1,1,1,1] row_mask:0xf bank_mask:0xf
  v_add_u32_dpp v198, v218, v212 quad_perm:[2,2,2,2] row_mask:0xf bank_mask:0xf
  v_add_u32_dpp v199, v218, v212 quad_perm:[3,3,3,3] row_mask:0xf bank_mask:0xf
  s_branch k2_w0_fin
k2_w0n_skip0:
  v_mfma_f32_16x16x32_bf16 v[88:91], v[152:155], v[120:123], v[88:91]
  v_mfma_f32_16x16x32_bf16 v[92:95], v[152:155], v[124:127], v[92:95]
  v_mfma_f32_16x16x32_bf16 v[96:99], v[152:155], v[128:131], v[96:99]
  v_mfma_f32_16x16x32_bf16 v[100:103], v[152:155], v[132:135], v[100:103]
  s_waitcnt lgkmcnt(0)
  v_mfma_f32_16x16x32_bf16 v[104:107], v[152:155], v[136:139], v[104:107]
  v_mfma_f32_16x16x32_bf16 v[108:111], v[152:155], v[140:143], v[108:111]
  v_mfma_f32_16x16x32_bf16 v[112:115], v[152:155], v[144:147], v[112:115]
  v_mfma_f32_16x16x32_bf16 v[116:119], v[152:155], v[148:151], v[116:119]
  s_branch k2_w0n_back0
k2_w0b_skip0:
  v_mfma_f32_16x16x32_bf16 v[88:91], v[156:159], v[120:123], v[88:91]
  v_mfma_f32_16x16x32_bf16 v[92:95], v[156:159], v[124:127], v[92:95]
  v_mfma_f32_16x16x32_bf16 v[96:99], v[156:159], v[128:131], v[96:99]
  v_mfma_f32_16x16x32_bf16 v[100:103], v[156:159], v[132:135], v[100:103]
  s_waitcnt lgkmcnt(0)
  v_mfma_f32_16x16x32_bf16 v[104:107], v[156:159], v[136:139], v[104:107]
  v_mfma_f32_16x16x32_bf16 v[108:111], v[156:159], v[140:143], v[108:111]
  v_mfma_f32_16x16x32_bf16 v[112:115], v[156:159], v[144:147], v[112:115]
  v_mfma_f32_16x16x32_bf16 v[116:119], v[156:159], v[148:151], v[116:119]
  s_branch k2_w0b_back0
k2_w1_again:
  s_sub_u32 s34, s48, s29
  s_lshl_b32 s34, s34, 6
  v_subrev_u32 v219, s34, v216
  ds_read_b128 v[160:163], v219
  s_waitcnt lgkmcnt(0)
  v_and_b32 v156, v152, v160
  v_and_b32 v157, v153, v161
  v_and_b32 v158, v154, v162
  v_and_b32 v159, v155, v163
  v_xor_b32 v152, v152, v156
  v_xor_b32 v153, v153, v157
  v_xor_b32 v154, v154, v158
  v_xor_b32 v155, v155, v159
  s_nop 0
  v_mfma_f32_16x16x32_bf16 v[88:91], v[156:159], v[120:123], 0
  v_mfma_f32_16x16x32_bf16 v[92:95], v[156:159], v[124:127], 0
  v_mfma_f32_16x16x32_bf16 v[96:99], v[156:159], v[128:131], 0
  v_mfma_f32_16x16x32_bf16 v[100:103], v[156:159], v[132:135], 0
  v_mfma_f32_16x16x32_bf16 v[104:107], v[156:159], v[136:139], 0
  v_mfma_f32_16x16x32_bf16 v[108:111], v[156:159], v[140:143], 0
  v_mfma_f32_16x16x32_bf16 v[112:115], v[156:159], v[144:147], 0
  v_mfma_f32_16x16x32_bf16 v[116:119], v[156:159], v[148:151], 0
  s_set_gpr_idx_on s31, gpr_idx(DST)
  s_add_u32 s30, s30, 1
  v_fmac_f32 v8, v164, v88
  v_fmac_f32 v9, v168, v92
  v_fmac_f32 v10, v172, v96
  v_fmac_f32 v11, v176, v100
  v_fmac_f32 v8, v165, v89
  v_fmac_f32 v9, v169, v93
  v_fmac_f32 v10, v173, v97
  v_fmac_f32 v11, v177, v101
  v_fmac_f32 v8, v166, v90
  v_fmac_f32 v9, v170, v94
  v_fmac_f32 v10, v174, v98
  v_fmac_f32 v11, v178, v102
  v_fmac_f32 v8, v167, v91
  v_fmac_f32 v9, v171, v95
  v_fmac_f32 v10, v175, v99
  v_fmac_f32 v11, v179, v103
  v_fmac_f32 v12, v180, v104
  v_fmac_f32 v13, v184, v108
  v_fmac_f32 v14, v188, v112
  v_fmac_f32 v15, v192, v116
  v_fmac_f32 v12, v181, v105
  v_fmac_f32 v13, v185, v109
  v_fmac_f32 v14, v189, v113
  v_fmac_f32 v15, v193, v117
  v_fmac_f32 v12, v182, v106
  v_fmac_f32 v13, v186, v110
  v_fmac_f32 v14, v190, v114
  v_fmac_f32 v15, v194, v118
  v_fmac_f32 v12, v183, v107
  v_fmac_f32 v13, v187, v111
  v_fmac_f32 v14, v191, v115
  v_fmac_f32 v15, v195, v119
  s_set_gpr_idx_off
  v_readlane_b32 s29, v215, s30
  s_add_u32 s31, s31, 16
  s_add_u32 s29, s29, s93
  s_branch k2_w1_more
k2_w1_evt:
  s_cmp_eq_u32 s48, s26
  s_cbranch_scc1 k2_w1_e2
  s_cmp_eq_u32 s48, s18
  s_cbranch_scc1 k2_w1_e4
  s_cmp_gt_u32 s48, s26
  s_cbranch_scc1 k2_w1_e3
  v_mov_b32 v214, v239
  v_add_u32 v212, 256, v212
  s_mov_b32 s28, s26
  s_branch k2_w1_top
k2_w1_e2:
  v_mov_b32 v213, v238
  s_add_u32 s28, s26, 32
  s_branch k2_w1_top
k2_w1_e3:
  v_lshlrev_b32 v219, 4, v217
  v_add_u32 v219, 154368, v219
  ds_read_b128 v[164:167], v219 offset:0
  ds_read_b128 v[168:171], v219 offset:1024
  ds_read_b128 v[172:175], v219 offset:2048
  ds_read_b128 v[176:179], v219 offset:3072
  ds_read_b128 v[180:183], v219 offset:4096
  ds_read_b128 v[184:187], v219 offset:5120
  ds_read_b128 v[188:191], v219 offset:6144
  ds_read_b128 v[192:195], v219 offset:7168
  v_mov_b64 v[88:89], 0
  v_mov_b64 v[90:91], 0
  v_mov_b64 v[92:93], 0
  v_mov_b64 v[94:95], 0
  v_mov_b64 v[96:97], 0
  v_mov_b64 v[98:99], 0
  v_mov_b64 v[100:101], 0
  v_mov_b64 v[102:103], 0
  v_mov_b64 v[104:105], 0
  v_mov_b64 v[106:107], 0
  v_mov_b64 v[108:109], 0
  v_mov_b64 v[110:111], 0
  v_mov_b64 v[112:113], 0
  v_mov_b64 v[114:115], 0
  v_mov_b64 v[116:117], 0
  v_mov_b64 v[118:119], 0
  s_mov_b32 s30, s49
  s_mov_b32 s31, 8
  s_mov_b32 s93, s26
  s_mov_b32 s28, s18
  v_readlane_b32 s29, v215, s49
  s_setprio 1
  s_cmp_ge_u32 s17, 4
  s_cbranch_scc0 k2_w1_pr
  s_setprio 0
k2_w1_pr:
  s_add_u32 s29, s29, s26
  s_branch k2_w1_top
k2_w1_e4:
  s_waitcnt vmcnt(0)
  s_mov_b32 s28, -1
  s_branch k2_w1_top
k2_w1_nextskip:
  v_lshlrev_b32 v224, 16, v220
  v_and_b32 v225, 0xffff0000, v220
  v_lshlrev_b32 v226, 16, v221
  v_and_b32 v227, 0xffff0000, v221
  v_and_or_b32 v236, v222, v248, v249
  v_perm_b32 v237, v223, v222, v250
  v_mul_f32 v228, v224, v236
  v_mul_f32 v229, v225, v236
  v_mul_f32 v230, v226, v236
  v_mul_f32 v231, v227, v236
  v_cvt_pk_bf16_f32 v232, v228, v229
  v_cvt_pk_bf16_f32 v233, v230, v231
  v_mul_f32 v228, v224, v237
  v_mul_f32 v229, v225, v237
  v_mul_f32 v230, v226, v237
  v_mul_f32 v231, v227, v237
  v_cvt_pk_bf16_f32 v234, v228, v229
  v_cvt_pk_bf16_f32 v235, v230, v231
  v_lshlrev_b32 v218, 9, v218
  v_add_u32 v213, 512, v213
  v_mfma_f32_16x16x32_bf16 v[224:227], v[232:235], v[240:243], 0
  v_mfma_f32_16x16x32_bf16 v[228:231], v[232:235], v[244:247], 0
  v_add_u32 v214, 512, v214
  v_add_u32_dpp v200, v218, v212 quad_perm:[0,0,0,0] row_mask:0xf bank_mask:0xf
  v_add_u32_dpp v201, v218, v212 quad_perm:[1,1,1,1] row_mask:0xf bank_mask:0xf
  v_add_u32_dpp v202, v218, v212 quad_perm:[2,2,2,2] row_mask:0xf bank_mask:0xf
  v_add_u32_dpp v203, v218, v212 quad_perm:[3,3,3,3] row_mask:0xf bank_mask:0xf
  s_branch k2_w1_fin
k2_w1n_skip0:
  v_mfma_f32_16x16x32_bf16 v[88:91], v[152:155], v[120:123], v[88:91]
  v_mfma_f32_16x16x32_bf16 v[92:95], v[152:155], v[124:127], v[92:95]
  v_mfma_f32_16x16x32_bf16 v[96:99], v[152:155], v[128:131], v[96:99]
  v_mfma_f32_16x16x32_bf16 v[100:103], v[152:155], v[132:135], v[100:103]
  s_waitcnt lgkmcnt(0)
  v_mfma_f32_16x16x32_bf16 v[104:107], v[152:155], v[136:139], v[104:107]
  v_mfma_f32_16x16x32_bf16 v[108:111], v[152:155], v[140:143], v[108:111]
  v_mfma_f32_16x16x32_bf16 v[112:115], v[152:155], v[144:147], v[112:115]
  v_mfma_f32_16x16x32_bf16 v[116:119], v[152:155], v[148:151], v[116:119]
  s_branch k2_w1n_back0
k2_w1b_skip0:
  v_mfma_f32_16x16x32_bf16 v[88:91], v[156:159], v[120:123], v[88:91]
  v_mfma_f32_16x16x32_bf16 v[92:95], v[156:159], v[124:127], v[92:95]
  v_mfma_f32_16x16x32_bf16 v[96:99], v[156:159], v[128:131], v[96:99]
  v_mfma_f32_16x16x32_bf16 v[100:103], v[156:159], v[132:135], v[100:103]
  s_waitcnt lgkmcnt(0)
  v_mfma_f32_16x16x32_bf16 v[104:107], v[156:159], v[136:139], v[104:107]
  v_mfma_f32_16x16x32_bf16 v[108:111], v[156:159], v[140:143], v[108:111]
  v_mfma_f32_16x16x32_bf16 v[112:115], v[156:159], v[144:147], v[112:115]
  v_mfma_f32_16x16x32_bf16 v[116:119], v[156:159], v[148:151], v[116:119]
  s_branch k2_w1b_back0
k2_w2_again:
  s_sub_u32 s34, s48, s29
  s_lshl_b32 s34, s34, 6
  v_subrev_u32 v219, s34, v216
  ds_read_b128 v[160:163], v219
  s_waitcnt lgkmcnt(0)
  v_and_b32 v156, v152, v160
  v_and_b32 v157, v153, v161
  v_and_b32 v158, v154, v162
  v_and_b32 v159, v155, v163
  v_xor_b32 v152, v152, v156
  v_xor_b32 v153, v153, v157
  v_xor_b32 v154, v154, v158
  v_xor_b32 v155, v155, v159
  s_nop 0
  v_mfma_f32_16x16x32_bf16 v[88:91], v[156:159], v[120:123], 0
  v_mfma_f32_16x16x32_bf16 v[92:95], v[156:159], v[124:127], 0
  v_mfma_f32_16x16x32_bf16 v[96:99], v[156:159], v[128:131], 0
  v_mfma_f32_16x16x32_bf16 v[100:103], v[156:159], v[132:135], 0
  v_mfma_f32_16x16x32_bf16 v[104:107], v[156:159], v[136:139], 0
  v_mfma_f32_16x16x32_bf16 v[108:111], v[156:159], v[140:143], 0
  v_mfma_f32_16x16x32_bf16 v[112:115], v[156:159], v[144:147], 0
  v_mfma_f32_16x16x32_bf16 v[116:119], v[156:159], v[148:151], 0
  s_set_gpr_idx_on s31, gpr_idx(DST)
  s_add_u32 s30, s30, 1
  v_fmac_f32 v8, v164, v88
  v_fmac_f32 v9, v168, v92
  v_fmac_f32 v10, v172, v96
  v_fmac_f32 v11, v176, v100
  v_fmac_f32 v8, v165, v89
  v_fmac_f32 v9, v169, v93
  v_fmac_f32 v10, v173, v97
  v_fmac_f32 v11, v177, v101
  v_fmac_f32 v8, v166, v90
  v_fmac_f32 v9, v170, v94
  v_fmac_f32 v10, v174, v98
  v_fmac_f32 v11, v178, v102
  v_fmac_f32 v8, v167, v91
  v_fmac_f32 v9, v171, v95
  v_fmac_f32 v10, v175, v99
  v_fmac_f32 v11, v179, v103
  v_fmac_f32 v12, v180, v104
  v_fmac_f32 v13, v184, v108
  v_fmac_f32 v14, v188, v112
  v_fmac_f32 v15, v192, v116
  v_fmac_f32 v12, v181, v105
  v_fmac_f32 v13, v185, v109
  v_fmac_f32 v14, v189, v113
  v_fmac_f32 v15, v193, v117
  v_fmac_f32 v12, v182, v106
  v_fmac_f32 v13, v186, v110
  v_fmac_f32 v14, v190, v114
  v_fmac_f32 v15, v194, v118
  v_fmac_f32 v12, v183, v107
  v_fmac_f32 v13, v187, v111
  v_fmac_f32 v14, v191, v115
  v_fmac_f32 v15, v195, v119
  s_set_gpr_idx_off
  v_readlane_b32 s29, v215, s30
  s_add_u32 s31, s31, 16
  s_add_u32 s29, s29, s93
  s_branch k2_w2_more
k2_w2_evt:
  s_cmp_eq_u32 s48, s26
  s_cbranch_scc1 k2_w2_e2
  s_cmp_eq_u32 s48, s18
  s_cbranch_scc1 k2_w2_e4
  s_cmp_gt_u32 s48, s26
  s_cbranch_scc1 k2_w2_e3
  v_mov_b32 v214, v239
  v_add_u32 v212, 256, v212
  s_mov_b32 s28, s26
  s_branch k2_w2_top
k2_w2_e2:
  v_mov_b32 v213, v238
  s_add_u32 s28, s26, 32
  s_branch k2_w2_top
k2_w2_e3:
  v_lshlrev_b32 v219, 4, v217
  v_add_u32 v219, 154368, v219
  ds_read_b128 v[164:167], v219 offset:0
  ds_read_b128 v[168:171], v219 offset:1024
  ds_read_b128 v[172:175], v219 offset:2048
  ds_read_b128 v[176:179], v219 offset:3072
  ds_read_b128 v[180:183], v219 offset:4096
  ds_read_b128 v[184:187], v219 offset:5120
  ds_read_b128 v[188:191], v219 offset:6144
  ds_read_b128 v[192:195], v219 offset:7168
  v_mov_b64 v[88:89], 0
  v_mov_b64 v[90:91], 0
  v_mov_b64 v[92:93], 0
  v_mov_b64 v[94:95], 0
  v_mov_b64 v[96:97], 0
  v_mov_b64 v[98:99], 0
  v_mov_b64 v[100:101], 0
  v_mov_b64 v[102:103], 0
  v_mov_b64 v[104:105], 0
  v_mov_b64 v[106:107], 0
  v_mov_b64 v[108:109], 0
  v_mov_b64 v[110:111], 0
  v_mov_b64 v[112:113], 0
  v_mov_b64 v[114:115], 0
  v_mov_b64 v[116:117], 0
  v_mov_b64 v[118:119], 0
  s_mov_b32 s30, s49
  s_mov_b32 s31, 8
  s_mov_b32 s93, s26
  s_mov_b32 s28, s18
  v_readlane_b32 s29, v215, s49
  s_setprio 1
  s_cmp_ge_u32 s17, 4
  s_cbranch_scc0 k2_w2_pr
  s_setprio 0
k2_w2_pr:
  s_add_u32 s29, s29, s26
  s_branch k2_w2_top
k2_w2_e4:
  s_waitcnt vmcnt(0)
  s_mov_b32 s28, -1
  s_branch k2_w2_top
k2_w2_nextskip:
  v_lshlrev_b32 v224, 16, v220
  v_and_b32 v225, 0xffff0000, v220
  v_lshlrev_b32 v226, 16, v221
  v_and_b32 v227, 0xffff0000, v221
  v_and_or_b32 v236, v222, v248, v249
  v_perm_b32 v237, v223, v222, v250
  v_mul_f32 v228, v224, v236
  v_mul_f32 v229, v225, v236
  v_mul_f32 v230, v226, v236
  v_mul_f32 v231, v227, v236
  v_cvt_pk_bf16_f32 v232, v228, v229
  v_cvt_pk_bf16_f32 v233, v230, v231
  v_mul_f32 v228, v224, v237
  v_mul_f32 v229, v225, v237
  v_mul_f32 v230, v226, v237
  v_mul_f32 v231, v227, v237
  v_cvt_pk_bf16_f32 v234, v228, v229
  v_cvt_pk_bf16_f32 v235, v230, v231
  v_lshlrev_b32 v218, 9, v218
  v_add_u32 v213, 512, v213
  v_mfma_f32_16x16x32_bf16 v[224:227], v[232:235], v[240:243], 0
  v_mfma_f32_16x16x32_bf16 v[228:231], v[232:235], v[244:247], 0
  v_add_u32 v214, 512, v214
  v_add_u32_dpp v204, v218, v212 quad_perm:[0,0,0,0] row_mask:0xf bank_mask:0xf
  v_add_u32_dpp v205, v218, v212 quad_perm:[1,1,1,1] row_mask:0xf bank_mask:0xf
  v_add_u32_dpp v206, v218, v212 quad_perm:[2,2,2,2] row_mask:0xf bank_mask:0xf
  v_add_u32_dpp v207, v218, v212 quad_perm:[3,3,3,3] row_mask:0xf bank_mask:0xf
  s_branch k2_w2_fin
k2_w2n_skip0:
  v_mfma_f32_16x16x32_bf16 v[88:91], v[152:155], v[120:123], v[88:91]
  v_mfma_f32_16x16x32_bf16 v[92:95], v[152:155], v[124:127], v[92:95]
  v_mfma_f32_16x16x32_bf16 v[96:99], v[152:155], v[128:131], v[96:99]
  v_mfma_f32_16x16x32_bf16 v[100:103], v[152:155], v[132:135], v[100:103]
  s_waitcnt lgkmcnt(0)
  v_mfma_f32_16x16x32_bf16 v[104:107], v[152:155], v[136:139], v[104:107]
  v_mfma_f32_16x16x32_bf16 v[108:111], v[152:155], v[140:143], v[108:111]
  v_mfma_f32_16x16x32_bf16 v[112:115], v[152:155], v[144:147], v[112:115]
  v_mfma_f32_16x16x32_bf16 v[116:119], v[152:155], v[148:151], v[116:119]
  s_branch k2_w2n_back0
k2_w2b_skip0:
  v_mfma_f32_16x16x32_bf16 v[88:91], v[156:159], v[120:123], v[88:91]
  v_mfma_f32_16x16x32_bf16 v[92:95], v[156:159], v[124:127], v[92:95]
  v_mfma_f32_16x16x32_bf16 v[96:99], v[156:159], v[128:131], v[96:99]
  v_mfma_f32_16x16x32_bf16 v[100:103], v[156:159], v[132:135], v[100:103]
  s_waitcnt lgkmcnt(0)
  v_mfma_f32_16x16x32_bf16 v[104:107], v[156:159], v[136:139], v[104:107]
  v_mfma_f32_16x16x32_bf16 v[108:111], v[156:159], v[140:143], v[108:111]
  v_mfma_f32_16x16x32_bf16 v[112:115], v[156:159], v[144:147], v[112:115]
  v_mfma_f32_16x16x32_bf16 v[116:119], v[156:159], v[148:151], v[116:119]
  s_branch k2_w2b_back0
k2_streamdone:
  s_setprio 0
  v_subrev_u32 v212, 256, v212
k2_roundend:
  s_add_u32 s21, s21, 2304
  s_cmp_lt_u32 s21, s20
  s_cbranch_scc1 k2_nextround
k2_final:
  s_and_b32 s34, s17, 3
  s_mul_i32 s35, s34, 10240
  s_add_u32 s35, s35, 278528
  v_lshlrev_b32 v4, 4, v217
  buffer_load_dwordx4 v[120:123], v4, s[8:11], s35 offen offset:0
  buffer_load_dwordx4 v[124:127], v4, s[8:11], s35 offen offset:1024
  buffer_load_dwordx4 v[128:131], v4, s[8:11], s35 offen offset:2048
  buffer_load_dwordx4 v[132:135], v4, s[8:11], s35 offen offset:3072
  s_add_u32 s35, s35, 4096
  buffer_load_dwordx4 v[136:139], v4, s[8:11], s35 offen offset:0
  buffer_load_dwordx4 v[140:143], v4, s[8:11], s35 offen offset:1024
  buffer_load_dwordx4 v[144:147], v4, s[8:11], s35 offen offset:2048
  buffer_load_dwordx4 v[148:151], v4, s[8:11], s35 offen offset:3072
  s_add_u32 s35, s35, 4096
  buffer_load_dwordx4 v[152:155], v4, s[8:11], s35 offen offset:0
  buffer_load_dwordx4 v[156:159], v4, s[8:11], s35 offen offset:1024
  v_cvt_pk_bf16_f32 v8, v8, v9
  v_cvt_pk_bf16_f32 v9, v10, v11
  v_cvt_pk_bf16_f32 v12, v12, v13
  v_cvt_pk_bf16_f32 v13, v14, v15
  v_cvt_pk_bf16_f32 v16, v16, v17
  v_cvt_pk_bf16_f32 v17, v18, v19
  v_cvt_pk_bf16_f32 v20, v20, v21
  v_cvt_pk_bf16_f32 v21, v22, v23
  v_cvt_pk_bf16_f32 v24, v24, v25
  v_cvt_pk_bf16_f32 v25, v26, v27
  v_cvt_pk_bf16_f32 v28, v28, v29
  v_cvt_pk_bf16_f32 v29, v30, v31
  v_cvt_pk_bf16_f32 v32, v32, v33
  v_cvt_pk_bf16_f32 v33, v34, v35
  v_cvt_pk_bf16_f32 v36, v36, v37
  v_cvt_pk_bf16_f32 v37, v38, v39
  v_cvt_pk_bf16_f32 v40, v40, v41
  v_cvt_pk_bf16_f32 v41, v42, v43
  v_cvt_pk_bf16_f32 v44, v44, v45
  v_cvt_pk_bf16_f32 v45, v46, v47
  v_cvt_pk_bf16_f32 v48, v48, v49
  v_cvt_pk_bf16_f32 v49, v50, v51
  v_cvt_pk_bf16_f32 v52, v52, v53
  v_cvt_pk_bf16_f32 v53, v54, v55
  v_cvt_pk_bf16_f32 v56, v56, v57
  v_cvt_pk_bf16_f32 v57, v58, v59
  v_cvt_pk_bf16_f32 v60, v60, v61
  v_cvt_pk_bf16_f32 v61, v62, v63
  v_cvt_pk_bf16_f32 v64, v64, v65
  v_cvt_pk_bf16_f32 v65, v66, v67
  v_cvt_pk_bf16_f32 v68, v68, v69
  v_cvt_pk_bf16_f32 v69, v70, v71
  v_cvt_pk_bf16_f32 v72, v72, v73
  v_cvt_pk_bf16_f32 v73, v74, v75
  v_cvt_pk_bf16_f32 v76, v76, v77
  v_cvt_pk_bf16_f32 v77, v78, v79
  v_cvt_pk_bf16_f32 v80, v80, v81
  v_cvt_pk_bf16_f32 v81, v82, v83
  v_cvt_pk_bf16_f32 v84, v84, v85
  v_cvt_pk_bf16_f32 v85, v86, v87
  s_mul_i32 s36, s17, 12320
  s_add_u32 s36, s36, 56064
  v_lshlrev_b32 v5, 3, v217
  v_add_u32 v5, s36, v5
  ds_write_b64 v5, v[8:9] offset:0
  ds_write_b64 v5, v[12:13] offset:512
  ds_write_b64 v5, v[16:17] offset:1024
  ds_write_b64 v5, v[20:21] offset:1536
  ds_write_b64 v5, v[24:25] offset:2048
  ds_write_b64 v5, v[28:29] offset:2560
  ds_write_b64 v5, v[32:33] offset:3072
  ds_write_b64 v5, v[36:37] offset:3584
  ds_write_b64 v5, v[40:41] offset:4096
  ds_write_b64 v5, v[44:45] offset:4608
  ds_write_b64 v5, v[48:49] offset:5120
  ds_write_b64 v5, v[52:53] offset:5632
  ds_write_b64 v5, v[56:57] offset:6144
  ds_write_b64 v5, v[60:61] offset:6656
  ds_write_b64 v5, v[64:65] offset:7168
  ds_write_b64 v5, v[68:69] offset:7680
  ds_write_b64 v5, v[72:73] offset:8192
  ds_write_b64 v5, v[76:77] offset:8704
  ds_write_b64 v5, v[80:81] offset:9216
  ds_write_b64 v5, v[84:85] offset:9728
  v_and_b32 v5, 15, v217
  v_lshrrev_b32 v6, 4, v217
  v_and_b32 v8, 7, v217
  v_bfe_u32 v9, v217, 3, 1
  v_mul_u32_u24 v7, 12320, v8
  v_lshl_add_u32 v7, v6, 4, v7
  v_add_u32 v7, 56064, v7
  v_add_u32 v39, 8192, v7
  v_lshl_add_u32 v7, v9, 11, v7
  s_lshl_b32 s38, s34, 5
  s_add_u32 s38, s38, 5888
  v_mul_u32_u24 v36, 528, v5
  v_lshl_add_u32 v36, v6, 3, v36
  v_add_u32 v36, s38, v36
  s_lshr_b32 s40, s17, 2
  s_lshl_b32 s41, s40, 12
  v_add_u32 v37, s41, v7
  s_mul_i32 s41, s40, 8448
  v_add_u32 v38, s41, v36
  v_mul_u32_u24 v40, 528, v8
  v_lshl_add_u32 v40, v6, 3, v40
  v_add_u32 v40, s38, v40
  v_add_u32 v40, 16896, v40
  v_lshl_add_u32 v41, v9, 7, v40
  v_mul_i32_i24 v10, 128, v9
  v_add_u32 v10, v10, v39
  v_mul_i32_i24 v11, 512, v9
  v_add_u32 v11, v11, v39
  v_mul_i32_i24 v12, -896, v9
  v_add_u32 v12, v12, v39
  v_mul_i32_i24 v13, 256, v9
  v_add_u32 v13, v13, v39
  s_waitcnt lgkmcnt(0)
  s_barrier
  s_cmp_lg_u32 s40, 0
  s_cbranch_scc1 k2_t2b
  ds_read_b128 v[164:167], v37 offset:0
  ds_read_b128 v[168:171], v37 offset:64
  ds_read_b128 v[172:175], v37 offset:640
  ds_read_b128 v[176:179], v37 offset:704
  ds_read_b128 v[180:183], v37 offset:1280
  ds_read_b128 v[184:187], v37 offset:1344
  ds_read_b128 v[188:191], v37 offset:1920
  ds_read_b128 v[192:195], v37 offset:1984
  ds_read_b128 v[196:199], v37 offset:128
  ds_read_b128 v[200:203], v37 offset:192
  ds_read_b128 v[204:207], v37 offset:512
  ds_read_b128 v[208:211], v37 offset:576
  ds_read_b128 v[212:215], v37 offset:1792
  ds_read_b128 v[216:219], v37 offset:1856
  ds_read_b128 v[220:223], v37 offset:1408
  ds_read_b128 v[224:227], v37 offset:1472
  s_waitcnt lgkmcnt(8)
  s_waitcnt vmcnt(6)
  v_mfma_f32_16x16x32_bf16 v[88:91], v[120:123], v[164:167], 0
  v_mfma_f32_16x16x32_bf16 v[88:91], v[124:127], v[168:171], v[88:91]
  v_mfma_f32_16x16x32_bf16 v[88:91], v[128:131], v[172:175], v[88:91]
  v_mfma_f32_16x16x32_bf16 v[88:91], v[132:135], v[176:179], v[88:91]
  v_mfma_f32_16x16x32_bf16 v[88:91], v[128:131], v[180:183], v[88:91]
  v_mfma_f32_16x16x32_bf16 v[88:91], v[132:135], v[184:187], v[88:91]
  v_mfma_f32_16x16x32_bf16 v[88:91], v[128:131], v[188:191], v[88:91]
  v_mfma_f32_16x16x32_bf16 v[88:91], v[132:135], v[192:195], v[88:91]
  ds_read_b128 v[164:167], v37 offset:256
  ds_read_b128 v[168:171], v37 offset:320
  ds_read_b128 v[172:175], v37 offset:1024
  ds_read_b128 v[176:179], v37 offset:1088
  ds_read_b128 v[180:183], v37 offset:896
  ds_read_b128 v[184:187], v37 offset:960
  ds_read_b128 v[188:191], v37 offset:1664
  ds_read_b128 v[192:195], v37 offset:1728
  s_waitcnt lgkmcnt(8)
  s_waitcnt vmcnt(0)
  v_mfma_f32_16x16x32_bf16 v[92:95], v[136:139], v[196:199], 0
  v_mfma_f32_16x16x32_bf16 v[92:95], v[140:143], v[200:203], v[92:95]
  v_mfma_f32_16x16x32_bf16 v[92:95], v[144:147], v[204:207], v[92:95]
  v_mfma_f32_16x16x32_bf16 v[92:95], v[148:151], v[208:211], v[92:95]
  v_mfma_f32_16x16x32_bf16 v[92:95], v[152:155], v[212:215], v[92:95]
  v_mfma_f32_16x16x32_bf16 v[92:95], v[156:159], v[216:219], v[92:95]
  v_mfma_f32_16x16x32_bf16 v[92:95], v[152:155], v[220:223], v[92:95]
  v_mfma_f32_16x16x32_bf16 v[92:95], v[156:159], v[224:227], v[92:95]
  ds_read_b128 v[196:199], v37 offset:384
  ds_read_b128 v[200:203], v37 offset:448
  ds_read_b128 v[204:207], v37 offset:1536
  ds_read_b128 v[208:211], v37 offset:1600
  ds_read_b128 v[212:215], v37 offset:1152
  ds_read_b128 v[216:219], v37 offset:1216
  ds_read_b128 v[220:223], v37 offset:768
  ds_read_b128 v[224:227], v37 offset:832
  s_waitcnt lgkmcnt(8)
  v_mfma_f32_16x16x32_bf16 v[96:99], v[136:139], v[164:167], 0
  v_mul_f32 v44, 0xbfb8aa3b, v88
  v_mul_f32 v45, 0xbfb8aa3b, v89
  v_mul_f32 v46, 0xbfb8aa3b, v90
  v_mfma_f32_16x16x32_bf16 v[96:99], v[140:143], v[168:171], v[96:99]
  v_mul_f32 v47, 0xbfb8aa3b, v91
  v_exp_f32 v44, v44
  v_exp_f32 v45, v45
  v_mfma_f32_16x16x32_bf16 v[96:99], v[144:147], v[172:175], v[96:99]
  v_exp_f32 v46, v46
  v_exp_f32 v47, v47
  s_nop 0
  v_mfma_f32_16x16x32_bf16 v[96:99], v[148:151], v[176:179], v[96:99]
  v_add_f32 v44, 1.0, v44
  v_add_f32 v45, 1.0, v45
  v_add_f32 v46, 1.0, v46
  v_mfma_f32_16x16x32_bf16 v[96:99], v[152:155], v[180:183], v[96:99]
  v_add_f32 v47, 1.0, v47
  v_rcp_f32 v44, v44
  v_rcp_f32 v45, v45
  v_mfma_f32_16x16x32_bf16 v[96:99], v[156:159], v[184:187], v[96:99]
  v_rcp_f32 v46, v46
  v_rcp_f32 v47, v47
  s_nop 0
  v_mfma_f32_16x16x32_bf16 v[96:99], v[152:155], v[188:191], v[96:99]
  v_mfma_f32_16x16x32_bf16 v[96:99], v[156:159], v[192:195], v[96:99]
  ds_read_b128 v[164:167], v39 offset:0
  ds_read_b128 v[168:171], v39 offset:64
  ds_read_b128 v[172:175], v39 offset:640
  ds_read_b128 v[176:179], v39 offset:704
  ds_read_b128 v[180:183], v39 offset:1280
  ds_read_b128 v[184:187], v39 offset:1344
  ds_read_b128 v[188:191], v39 offset:1920
  ds_read_b128 v[192:195], v39 offset:1984
  s_waitcnt lgkmcnt(8)
  v_mfma_f32_16x16x32_bf16 v[100:103], v[136:139], v[196:199], 0
  v_cvt_pk_bf16_f32 v52, v88, v89
  v_mfma_f32_16x16x32_bf16 v[100:103], v[140:143], v[200:203], v[100:103]
  v_cvt_pk_bf16_f32 v53, v90, v91
  v_mfma_f32_16x16x32_bf16 v[100:103], v[144:147], v[204:207], v[100:103]
  ds_write_b64 v38, v[52:53] offset:0
  v_mfma_f32_16x16x32_bf16 v[100:103], v[148:151], v[208:211], v[100:103]
  v_mfma_f32_16x16x32_bf16 v[100:103], v[152:155], v[212:215], v[100:103]
  v_mfma_f32_16x16x32_bf16 v[100:103], v[156:159], v[216:219], v[100:103]
  v_mfma_f32_16x16x32_bf16 v[100:103], v[152:155], v[220:223], v[100:103]
  v_mfma_f32_16x16x32_bf16 v[100:103], v[156:159], v[224:227], v[100:103]
  ds_read_b128 v[196:199], v10 offset:128
  ds_read_b128 v[200:203], v10 offset:192
  ds_read_b128 v[204:207], v11 offset:512
  ds_read_b128 v[208:211], v11 offset:576
  ds_read_b128 v[212:215], v12 offset:1792
  ds_read_b128 v[216:219], v12 offset:1856
  ds_read_b128 v[220:223], v13 offset:1408
  ds_read_b128 v[224:227], v13 offset:1472
  s_waitcnt lgkmcnt(8)
  v_mfma_f32_16x16x32_bf16 v[104:107], v[120:123], v[164:167], 0
  v_mul_f32 v92, v92, v44
  v_mfma_f32_16x16x32_bf16 v[104:107], v[124:127], v[168:171], v[104:107]
  v_mul_f32 v93, v93, v45
  v_mfma_f32_16x16x32_bf16 v[104:107], v[128:131], v[172:175], v[104:107]
  v_mul_f32 v94, v94, v46
  v_mfma_f32_16x16x32_bf16 v[104:107], v[132:135], v[176:179], v[104:107]
  v_mul_f32 v95, v95, v47
  v_mfma_f32_16x16x32_bf16 v[104:107], v[128:131], v[180:183], v[104:107]
  v_cvt_pk_bf16_f32 v54, v92, v93
  v_mfma_f32_16x16x32_bf16 v[104:107], v[132:135], v[184:187], v[104:107]
  v_cvt_pk_bf16_f32 v55, v94, v95
  v_mfma_f32_16x16x32_bf16 v[104:107], v[128:131], v[188:191], v[104:107]
  ds_write_b64 v38, v[54:55] offset:128
  v_mfma_f32_16x16x32_bf16 v[104:107], v[132:135], v[192:195], v[104:107]
  s_waitcnt lgkmcnt(0)
  v_mfma_f32_16x16x32_bf16 v[108:111], v[136:139], v[196:199], 0
  v_mul_f32 v96, v96, v44
  v_mfma_f32_16x16x32_bf16 v[108:111], v[140:143], v[200:203], v[108:111]
  v_mul_f32 v97, v97, v45
  v_mfma_f32_16x16x32_bf16 v[108:111], v[144:147], v[204:207], v[108:111]
  v_mul_f32 v98, v98, v46
  v_mfma_f32_16x16x32_bf16 v[108:111], v[148:151], v[208:211], v[108:111]
  v_mul_f32 v99, v99, v47
  v_mfma_f32_16x16x32_bf16 v[108:111], v[152:155], v[212:215], v[108:111]
  v_cvt_pk_bf16_f32 v56, v96, v97
  v_mfma_f32_16x16x32_bf16 v[108:111], v[156:159], v[216:219], v[108:111]
  v_cvt_pk_bf16_f32 v57, v98, v99
  v_mfma_f32_16x16x32_bf16 v[108:111], v[152:155], v[220:223], v[108:111]
  ds_write_b64 v38, v[56:57] offset:256
  v_mfma_f32_16x16x32_bf16 v[108:111], v[156:159], v[224:227], v[108:111]
  s_nop 1
  v_mul_f32 v100, v100, v44
  v_mul_f32 v101, v101, v45
  v_mul_f32 v102, v102, v46
  v_mul_f32 v103, v103, v47
  v_cvt_pk_bf16_f32 v58, v100, v101
  v_cvt_pk_bf16_f32 v59, v102, v103
  ds_write_b64 v38, v[58:59] offset:384
  v_mul_f32 v48, 0xbfb8aa3b, v104
  v_mul_f32 v49, 0xbfb8aa3b, v105
  v_mul_f32 v50, 0xbfb8aa3b, v106
  v_mul_f32 v51, 0xbfb8aa3b, v107
  v_exp_f32 v48, v48
  v_exp_f32 v49, v49
  v_exp_f32 v50, v50
  v_exp_f32 v51, v51
  s_nop 0
  v_add_f32 v48, 1.0, v48
  v_add_f32 v49, 1.0, v49
  v_add_f32 v50, 1.0, v50
  v_add_f32 v51, 1.0, v51
  v_rcp_f32 v48, v48
  v_rcp_f32 v49, v49
  v_rcp_f32 v50, v50
  v_rcp_f32 v51, v51
  s_nop 0
  v_mul_f32 v108, v108, v48
  v_mul_f32 v109, v109, v49
  v_mul_f32 v110, v110, v50
  v_mul_f32 v111, v111, v51
  v_cvt_pk_bf16_f32 v62, v108, v109
  v_cvt_pk_bf16_f32 v63, v110, v111
  ds_write_b64 v41, v[62:63] offset:128
  v_cmp_gt_u32 vcc, 8, v5
  s_and_saveexec_b64 s[54:55], vcc
  v_cvt_pk_bf16_f32 v60, v104, v105
  v_cvt_pk_bf16_f32 v61, v106, v107
  ds_write_b64 v40, v[60:61] offset:0
  s_mov_b64 exec, -1
  v_bfe_u32 v10, v0, 5, 1
  v_and_b32 v11, 31, v0
  s_lshl_b32 s38, s17, 1
  v_add_u32 v10, s38, v10
  v_mul_u32_u24 v12, 528, v10
  v_lshl_add_u32 v12, v11, 4, v12
  v_lshlrev_b32 v13, 9, v10
  v_lshl_add_u32 v13, v11, 4, v13
  s_mul_i32 s39, s16, 20480
  s_waitcnt lgkmcnt(0)
  s_barrier
  ds_read_b128 v[16:19], v12 offset:5888
  ds_read_b128 v[20:23], v12 offset:14336
  ds_read_b128 v[24:27], v12 offset:22784
  s_waitcnt lgkmcnt(2)
  buffer_store_dwordx4 v[16:19], v13, s[12:15], s39 offen sc1
  s_add_u32 s39, s39, 8192
  s_waitcnt lgkmcnt(1)
  buffer_store_dwordx4 v[20:23], v13, s[12:15], s39 offen sc1
  s_add_u32 s39, s39, 8192
  s_waitcnt lgkmcnt(0)
  buffer_store_dwordx4 v[24:27], v13, s[12:15], s39 offen sc1
  s_endpgm
k2_t2b:
  ds_read_b128 v[164:167], v37 offset:0
  ds_read_b128 v[168:171], v37 offset:64
  ds_read_b128 v[172:175], v37 offset:640
  ds_read_b128 v[176:179], v37 offset:704
  ds_read_b128 v[180:183], v37 offset:1280
  ds_read_b128 v[184:187], v37 offset:1344
  ds_read_b128 v[188:191], v37 offset:1920
  ds_read_b128 v[192:195], v37 offset:1984
  ds_read_b128 v[196:199], v37 offset:128
  ds_read_b128 v[200:203], v37 offset:192
  ds_read_b128 v[204:207], v37 offset:512
  ds_read_b128 v[208:211], v37 offset:576
  ds_read_b128 v[212:215], v37 offset:1792
  ds_read_b128 v[216:219], v37 offset:1856
  ds_read_b128 v[220:223], v37 offset:1408
  ds_read_b128 v[224:227], v37 offset:1472
  s_waitcnt lgkmcnt(8)
  s_waitcnt vmcnt(6)
  v_mfma_f32_16x16x32_bf16 v[88:91], v[120:123], v[164:167], 0
  v_mfma_f32_16x16x32_bf16 v[88:91], v[124:127], v[168:171], v[88:91]
  v_mfma_f32_16x16x32_bf16 v[88:91], v[128:131], v[172:175], v[88:91]
  v_mfma_f32_16x16x32_bf16 v[88:91], v[132:135], v[176:179], v[88:91]
  v_mfma_f32_16x16x32_bf16 v[88:91], v[128:131], v[180:183], v[88:91]
  v_mfma_f32_16x16x32_bf16 v[88:91], v[132:135], v[184:187], v[88:91]
  v_mfma_f32_16x16x32_bf16 v[88:91], v[128:131], v[188:191], v[88:91]
  v_mfma_f32_16x16x32_bf16 v[88:91], v[132:135], v[192:195], v[88:91]
  ds_read_b128 v[164:167], v37 offset:256
  ds_read_b128 v[168:171], v37 offset:320
  ds_read_b128 v[172:175], v37 offset:1024
  ds_read_b128 v[176:179], v37 offset:1088
  ds_read_b128 v[180:183], v37 offset:896
  ds_read_b128 v[184:187], v37 offset:960
  ds_read_b128 v[188:191], v37 offset:1664
  ds_read_b128 v[192:195], v37 offset:1728
  s_waitcnt lgkmcnt(8)
  s_waitcnt vmcnt(0)
  v_mfma_f32_16x16x32_bf16 v[92:95], v[136:139], v[196:199], 0
  v_mfma_f32_16x16x32_bf16 v[92:95], v[140:143], v[200:203], v[92:95]
  v_mfma_f32_16x16x32_bf16 v[92:95], v[144:147], v[204:207], v[92:95]
  v_mfma_f32_16x16x32_bf16 v[92:95], v[148:151], v[208:211], v[92:95]
  v_mfma_f32_16x16x32_bf16 v[92:95], v[152:155], v[212:215], v[92:95]
  v_mfma_f32_16x16x32_bf16 v[92:95], v[156:159], v[216:219], v[92:95]
  v_mfma_f32_16x16x32_bf16 v[92:95], v[152:155], v[220:223], v[92:95]
  v_mfma_f32_16x16x32_bf16 v[92:95], v[156:159], v[224:227], v[92:95]
  ds_read_b128 v[196:199], v37 offset:384
  ds_read_b128 v[200:203], v37 offset:448
  ds_read_b128 v[204:207], v37 offset:1536
  ds_read_b128 v[208:211], v37 offset:1600
  ds_read_b128 v[212:215], v37 offset:1152
  ds_read_b128 v[216:219], v37 offset:1216
  ds_read_b128 v[220:223], v37 offset:768
  ds_read_b128 v[224:227], v37 offset:832
  s_waitcnt lgkmcnt(8)
  v_mfma_f32_16x16x32_bf16 v[96:99], v[136:139], v[164:167], 0
  v_mul_f32 v44, 0xbfb8aa3b, v88
  v_mul_f32 v45, 0xbfb8aa3b, v89
  v_mul_f32 v46, 0xbfb8aa3b, v90
  v_mfma_f32_16x16x32_bf16 v[96:99], v[140:143], v[168:171], v[96:99]
  v_mul_f32 v47, 0xbfb8aa3b, v91
  v_exp_f32 v44, v44
  v_exp_f32 v45, v45
  v_mfma_f32_16x16x32_bf16 v[96:99], v[144:147], v[172:175], v[96:99]
  v_exp_f32 v46, v46
  v_exp_f32 v47, v47
  s_nop 0
  v_mfma_f32_16x16x32_bf16 v[96:99], v[148:151], v[176:179], v[96:99]
  v_add_f32 v44, 1.0, v44
  v_add_f32 v45, 1.0, v45
  v_add_f32 v46, 1.0, v46
  v_mfma_f32_16x16x32_bf16 v[96:99], v[152:155], v[180:183], v[96:99]
  v_add_f32 v47, 1.0, v47
  v_rcp_f32 v44, v44
  v_rcp_f32 v45, v45
  v_mfma_f32_16x16x32_bf16 v[96:99], v[156:159], v[184:187], v[96:99]
  v_rcp_f32 v46, v46
  v_rcp_f32 v47, v47
  s_nop 0
  v_mfma_f32_16x16x32_bf16 v[96:99], v[152:155], v[188:191], v[96:99]
  v_mfma_f32_16x16x32_bf16 v[96:99], v[156:159], v[192:195], v[96:99]
  ds_read_b128 v[164:167], v39 offset:0
  ds_read_b128 v[168:171], v39 offset:64
  ds_read_b128 v[172:175], v39 offset:640
  ds_read_b128 v[176:179], v39 offset:704
  ds_read_b128 v[180:183], v39 offset:1280
  ds_read_b128 v[184:187], v39 offset:1344
  ds_read_b128 v[188:191], v39 offset:1920
  ds_read_b128 v[192:195], v39 offset:1984
  s_waitcnt lgkmcnt(8)
  v_mfma_f32_16x16x32_bf16 v[100:103], v[136:139], v[196:199], 0
  v_cvt_pk_bf16_f32 v52, v88, v89
  v_mfma_f32_16x16x32_bf16 v[100:103], v[140:143], v[200:203], v[100:103]
  v_cvt_pk_bf16_f32 v53, v90, v91
  v_mfma_f32_16x16x32_bf16 v[100:103], v[144:147], v[204:207], v[100:103]
  ds_write_b64 v38, v[52:53] offset:0
  v_mfma_f32_16x16x32_bf16 v[100:103], v[148:151], v[208:211], v[100:103]
  v_mfma_f32_16x16x32_bf16 v[100:103], v[152:155], v[212:215], v[100:103]
  v_mfma_f32_16x16x32_bf16 v[100:103], v[156:159], v[216:219], v[100:103]
  v_mfma_f32_16x16x32_bf16 v[100:103], v[152:155], v[220:223], v[100:103]
  v_mfma_f32_16x16x32_bf16 v[100:103], v[156:159], v[224:227], v[100:103]
  ds_read_b128 v[196:199], v39 offset:384
  ds_read_b128 v[200:203], v39 offset:448
  ds_read_b128 v[204:207], v39 offset:1536
  ds_read_b128 v[208:211], v39 offset:1600
  ds_read_b128 v[212:215], v39 offset:1152
  ds_read_b128 v[216:219], v39 offset:1216
  ds_read_b128 v[220:223], v39 offset:768
  ds_read_b128 v[224:227], v39 offset:832
  s_waitcnt lgkmcnt(8)
  v_mfma_f32_16x16x32_bf16 v[104:107], v[120:123], v[164:167], 0
  v_mul_f32 v92, v92, v44
  v_mfma_f32_16x16x32_bf16 v[104:107], v[124:127], v[168:171], v[104:107]
  v_mul_f32 v93, v93, v45
  v_mfma_f32_16x16x32_bf16 v[104:107], v[128:131], v[172:175], v[104:107]
  v_mul_f32 v94, v94, v46
  v_mfma_f32_16x16x32_bf16 v[104:107], v[132:135], v[176:179], v[104:107]
  v_mul_f32 v95, v95, v47
  v_mfma_f32_16x16x32_bf16 v[104:107], v[128:131], v[180:183], v[104:107]
  v_cvt_pk_bf16_f32 v54, v92, v93
  v_mfma_f32_16x16x32_bf16 v[104:107], v[132:135], v[184:187], v[104:107]
  v_cvt_pk_bf16_f32 v55, v94, v95
  v_mfma_f32_16x16x32_bf16 v[104:107], v[128:131], v[188:191], v[104:107]
  ds_write_b64 v38, v[54:55] offset:128
  v_mfma_f32_16x16x32_bf16 v[104:107], v[132:135], v[192:195], v[104:107]
  s_waitcnt lgkmcnt(0)
  v_mfma_f32_16x16x32_bf16 v[108:111], v[136:139], v[196:199], 0
  v_mul_f32 v96, v96, v44
  v_mfma_f32_16x16x32_bf16 v[108:111], v[140:143], v[200:203], v[108:111]
  v_mul_f32 v97, v97, v45
  v_mfma_f32_16x16x32_bf16 v[108:111], v[144:147], v[204:207], v[108:111]
  v_mul_f32 v98, v98, v46
  v_mfma_f32_16x16x32_bf16 v[108:111], v[148:151], v[208:211], v[108:111]
  v_mul_f32 v99, v99, v47
  v_mfma_f32_16x16x32_bf16 v[108:111], v[152:155], v[212:215], v[108:111]
  v_cvt_pk_bf16_f32 v56, v96, v97
  v_mfma_f32_16x16x32_bf16 v[108:111], v[156:159], v[216:219], v[108:111]
  v_cvt_pk_bf16_f32 v57, v98, v99
  v_mfma_f32_16x16x32_bf16 v[108:111], v[152:155], v[220:223], v[108:111]
  ds_write_b64 v38, v[56:57] offset:256
  v_mfma_f32_16x16x32_bf16 v[108:111], v[156:159], v[224:227], v[108:111]
  s_nop 1
  v_mul_f32 v100, v100, v44
  v_mul_f32 v101, v101, v45
  v_mul_f32 v102, v102, v46
  v_mul_f32 v103, v103, v47
  v_cvt_pk_bf16_f32 v58, v100, v101
  v_cvt_pk_bf16_f32 v59, v102, v103
  ds_write_b64 v38, v[58:59] offset:384
  v_mul_f32 v48, 0xbfb8aa3b, v104
  v_mul_f32 v49, 0xbfb8aa3b, v105
  v_mul_f32 v50, 0xbfb8aa3b, v106
  v_mul_f32 v51, 0xbfb8aa3b, v107
  v_exp_f32 v48, v48
  v_exp_f32 v49, v49
  v_exp_f32 v50, v50
  v_exp_f32 v51, v51
  s_nop 0
  v_add_f32 v48, 1.0, v48
  v_add_f32 v49, 1.0, v49
  v_add_f32 v50, 1.0, v50
  v_add_f32 v51, 1.0, v51
  v_rcp_f32 v48, v48
  v_rcp_f32 v49, v49
  v_rcp_f32 v50, v50
  v_rcp_f32 v51, v51
  s_nop 0
  v_cmp_gt_u32 vcc, 8, v5
  s_and_saveexec_b64 s[54:55], vcc
  v_mul_f32 v108, v108, v48
  v_mul_f32 v109, v109, v49
  v_mul_f32 v110, v110, v50
  v_mul_f32 v111, v111, v51
  v_cvt_pk_bf16_f32 v62, v108, v109
  v_cvt_pk_bf16_f32 v63, v110, v111
  ds_write_b64 v40, v[62:63] offset:384
  s_mov_b64 exec, -1
  v_bfe_u32 v10, v0, 5, 1
  v_and_b32 v11, 31, v0
  s_lshl_b32 s38, s17, 1
  v_add_u32 v10, s38, v10
  v_mul_u32_u24 v12, 528, v10
  v_lshl_add_u32 v12, v11, 4, v12
  v_lshlrev_b32 v13, 9, v10
  v_lshl_add_u32 v13, v11, 4, v13
  s_mul_i32 s39, s16, 20480
  s_waitcnt lgkmcnt(0)
  s_barrier
  ds_read_b128 v[16:19], v12 offset:5888
  ds_read_b128 v[20:23], v12 offset:14336
  s_waitcnt lgkmcnt(1)
  buffer_store_dwordx4 v[16:19], v13, s[12:15], s39 offen sc1
  s_add_u32 s39, s39, 8192
  s_waitcnt lgkmcnt(0)
  buffer_store_dwordx4 v[20:23], v13, s[12:15], s39 offen sc1
  s_endpgm
k2_slow:
  s_waitcnt vmcnt(0) lgkmcnt(0)
  v_lshlrev_b32 v196, 10, v0
  s_lshl_b32 s34, s16, 2
  v_mov_b32 v3, 0
  v_cmp_gt_u32 vcc, 250, v0
  s_and_saveexec_b64 s[54:55], vcc
  s_cbranch_execz k2_notab
  buffer_load_dword v3, v196, s[8:11], s34 offen offset:0
k2_notab:
  s_mov_b64 exec, s[54:55]
  s_waitcnt vmcnt(0)
  v_lshrrev_b32 v4, 16, v3
  v_and_b32 v3, 0xffff, v3
  v_mov_b32 v5, v4
  s_nop 1
  v_add_u32_dpp v5, v5, v5 row_shr:1 row_mask:0xf bank_mask:0xf bound_ctrl:1
  s_nop 1
  v_add_u32_dpp v5, v5, v5 row_shr:2 row_mask:0xf bank_mask:0xf bound_ctrl:1
  s_nop 1
  v_add_u32_dpp v5, v5, v5 row_shr:4 row_mask:0xf bank_mask:0xf bound_ctrl:1
  s_nop 1
  v_add_u32_dpp v5, v5, v5 row_shr:8 row_mask:0xf bank_mask:0xf bound_ctrl:1
  s_nop 1
  v_add_u32_dpp v5, v5, v5 row_bcast:15 row_mask:0xa bank_mask:0xf
  s_nop 1
  v_add_u32_dpp v5, v5, v5 row_bcast:31 row_mask:0xc bank_mask:0xf
  s_nop 0
  v_readlane_b32 s34, v5, 63
  s_cmp_ge_u32 s17, 4
  s_cbranch_scc1 k2_nowtot
  s_lshl_b32 s35, s17, 2
  s_add_u32 s35, s35, 3152
  v_mov_b32 v6, s35
  v_mov_b32 v7, s34
  ds_write_b32 v6, v7
k2_nowtot:
  s_waitcnt lgkmcnt(0)
  s_barrier
  v_mov_b32 v6, 3152
  ds_read_b128 v[200:203], v6
  s_waitcnt lgkmcnt(0)
  v_readfirstlane_b32 s34, v200
  v_readfirstlane_b32 s35, v201
  v_readfirstlane_b32 s36, v202
  v_readfirstlane_b32 s37, v203
  s_add_u32 s38, s34, s35
  s_add_u32 s39, s38, s36
  s_add_u32 s20, s39, s37
  s_mov_b32 s40, 0
  s_cmp_eq_u32 s17, 1
  s_cselect_b32 s40, s34, s40
  s_cmp_eq_u32 s17, 2
  s_cselect_b32 s40, s38, s40
  s_cmp_eq_u32 s17, 3
  s_cselect_b32 s40, s39, s40
  s_cmp_ge_u32 s17, 4
  s_cbranch_scc1 k2_round
  v_lshlrev_b32 v7, 2, v0
  v_sub_u32 v5, v5, v4
  v_add_u32 v5, s40, v5
  v_mul_u32_u24 v6, 2560, v0
  v_add_u32 v6, v6, v3
  v_sub_u32 v6, v6, v5
  v_add_u32 v196, 1, v0
  v_lshl_or_b32 v6, v196, 20, v6
  v_mov_b32 v197, 0
  v_mov_b32 v198, 0x7fffffff
  v_cmp_lt_u32 vcc, 0, v4
  s_nop 1
  v_cndmask_b32 v6, v197, v6, vcc
  v_cmp_gt_u32 vcc, 250, v0
  s_nop 1
  v_cndmask_b32 v5, v198, v5, vcc
  ds_write_b32 v7, v5 offset:3168
  ds_write_b32 v7, v6 offset:4192
  s_branch k2_round
k2_nextround:
  v_lshlrev_b32 v198, 4, v217
  s_mov_b32 s34, 262144
  buffer_load_dwordx4 v[164:167], v198, s[8:11], s34 offen offset:0
  buffer_load_dwordx4 v[168:171], v198, s[8:11], s34 offen offset:1024
  buffer_load_dwordx4 v[172:175], v198, s[8:11], s34 offen offset:2048
  buffer_load_dwordx4 v[176:179], v198, s[8:11], s34 offen offset:3072
  s_add_u32 s34, s34, 4096
  buffer_load_dwordx4 v[180:183], v198, s[8:11], s34 offen offset:0
  buffer_load_dwordx4 v[184:187], v198, s[8:11], s34 offen offset:1024
  buffer_load_dwordx4 v[188:191], v198, s[8:11], s34 offen offset:2048
  buffer_load_dwordx4 v[192:195], v198, s[8:11], s34 offen offset:3072
  s_waitcnt vmcnt(0) lgkmcnt(0)
k2_round:
  s_waitcnt lgkmcnt(0)
  s_barrier
  v_mov_b32 v200, 0
  v_mov_b32 v201, 0
  v_mov_b32 v202, 0
  v_mov_b32 v203, 0
  v_lshlrev_b32 v6, 4, v0
  ds_write_b128 v6, v[200:203] offset:5888
  v_cmp_gt_u32 vcc, 256, v0
  s_and_saveexec_b64 s[54:55], vcc
  s_cbranch_execz k2_z1
  ds_write_b128 v6, v[200:203] offset:14080
k2_z1:
  s_mov_b64 exec, s[54:55]
  v_lshlrev_b32 v7, 2, v0
  v_cmp_gt_u32 vcc, 132, v0
  s_and_saveexec_b64 s[54:55], vcc
  s_cbranch_execz k2_z2
  ds_write_b32 v7, v200 offset:2112
k2_z2:
  s_mov_b64 exec, s[54:55]
  s_waitcnt lgkmcnt(0)
  s_barrier
  s_sub_u32 s22, s20, s21
  s_min_u32 s22, s22, 2304
  s_add_u32 s23, s22, 511
  s_lshr_b32 s23, s23, 9
  s_mov_b32 s51, s23
  s_lshl_b32 s23, s23, 6
  s_cmp_ge_u32 s17, 4
  s_cbranch_scc1 k2_nomark
  ds_read_b32 v5, v7 offset:3168
  ds_read_b32 v6, v7 offset:4192
  s_waitcnt lgkmcnt(0)
  v_subrev_u32 v5, s21, v5
  v_cmp_gt_u32 vcc, s22, v5
  v_cmp_ne_u32 s[34:35], 0, v6
  s_nop 0
  s_and_b64 vcc, vcc, s[34:35]
  s_and_saveexec_b64 s[54:55], vcc
  s_cbranch_execz k2_nomark1
  v_lshlrev_b32 v5, 2, v5
  ds_write_b32 v5, v6 offset:5888
k2_nomark1:
  s_mov_b64 exec, s[54:55]
k2_nomark:
  s_waitcnt lgkmcnt(0)
  s_barrier
  s_mul_i32 s42, s17, s23
  s_add_u32 s43, s42, s21
  s_mov_b64 s[56:57], 0
  s_mov_b64 s[58:59], 0
  s_mov_b64 s[60:61], 0
  s_mov_b64 s[62:63], 0
  s_mov_b64 s[64:65], 0
  s_mov_b64 s[66:67], 0
  s_mov_b64 s[68:69], 0
  s_mov_b64 s[70:71], 0
  s_mov_b64 s[72:73], 0
  s_mov_b64 s[74:75], 0
  s_mov_b64 s[76:77], 0
  s_mov_b64 s[78:79], 0
  s_mov_b64 s[80:81], 0
  s_mov_b64 s[82:83], 0
  s_mov_b64 s[84:85], 0
  s_mov_b64 s[86:87], 0
  s_mov_b32 s52, 1048576
  s_mov_b32 s53, 327680
  s_cmp_ge_u32 s42, s22
  s_cbranch_scc1 k2_loaded
  v_lshlrev_b32 v6, 4, v217
  ds_read_b128 v[200:203], v6 offset:3168
  v_add_u32 v196, s42, v217
  v_lshlrev_b32 v197, 2, v196
  ds_read_b32 v136, v197 offset:5888
  ds_read_b32 v137, v197 offset:6144
  ds_read_b32 v138, v197 offset:6400
  ds_read_b32 v139, v197 offset:6656
  ds_read_b32 v140, v197 offset:6912
  ds_read_b32 v141, v197 offset:7168
  s_waitcnt lgkmcnt(6)
  s_mov_b32 s34, 0
  v_cmp_ge_u32 vcc, s43, v200
  s_bcnt1_i32_b64 s35, vcc
  s_add_u32 s34, s34, s35
  v_cmp_ge_u32 vcc, s43, v201
  s_bcnt1_i32_b64 s35, vcc
  s_add_u32 s34, s34, s35
  v_cmp_ge_u32 vcc, s43, v202
  s_bcnt1_i32_b64 s35, vcc
  s_add_u32 s34, s34, s35
  v_cmp_ge_u32 vcc, s43, v203
  s_bcnt1_i32_b64 s35, vcc
  s_add_u32 s34, s34, s35
  s_sub_u32 s34, s34, 1
  s_lshl_b32 s34, s34, 2
  s_add_u32 s34, s34, 4192
  v_mov_b32 v198, s34
  ds_read_b32 v198, v198
  s_waitcnt lgkmcnt(0)
  v_readfirstlane_b32 s50, v198
  v_max_u32_dpp v136, v136, v136 row_shr:1 row_mask:0xf bank_mask:0xf bound_ctrl:1
  v_max_u32_dpp v137, v137, v137 row_shr:1 row_mask:0xf bank_mask:0xf bound_ctrl:1
  v_max_u32_dpp v138, v138, v138 row_shr:1 row_mask:0xf bank_mask:0xf bound_ctrl:1
  v_max_u32_dpp v139, v139, v139 row_shr:1 row_mask:0xf bank_mask:0xf bound_ctrl:1
  v_max_u32_dpp v140, v140, v140 row_shr:1 row_mask:0xf bank_mask:0xf bound_ctrl:1
  v_max_u32_dpp v141, v141, v141 row_shr:1 row_mask:0xf bank_mask:0xf bound_ctrl:1
  v_max_u32_dpp v136, v136, v136 row_shr:2 row_mask:0xf bank_mask:0xf bound_ctrl:1
  v_max_u32_dpp v137, v137, v137 row_shr:2 row_mask:0xf bank_mask:0xf bound_ctrl:1
  v_max_u32_dpp v138, v138, v138 row_shr:2 row_mask:0xf bank_mask:0xf bound_ctrl:1
  v_max_u32_dpp v139, v139, v139 row_shr:2 row_mask:0xf bank_mask:0xf bound_ctrl:1
  v_max_u32_dpp v140, v140, v140 row_shr:2 row_mask:0xf bank_mask:0xf bound_ctrl:1
  v_max_u32_dpp v141, v141, v141 row_shr:2 row_mask:0xf bank_mask:0xf bound_ctrl:1
  v_max_u32_dpp v136, v136, v136 row_shr:4 row_mask:0xf bank_mask:0xf bound_ctrl:1
  v_max_u32_dpp v137, v137, v137 row_shr:4 row_mask:0xf bank_mask:0xf bound_ctrl:1
  v_max_u32_dpp v138, v138, v138 row_shr:4 row_mask:0xf bank_mask:0xf bound_ctrl:1
  v_max_u32_dpp v139, v139, v139 row_shr:4 row_mask:0xf bank_mask:0xf bound_ctrl:1
  v_max_u32_dpp v140, v140, v140 row_shr:4 row_mask:0xf bank_mask:0xf bound_ctrl:1
  v_max_u32_dpp v141, v141, v141 row_shr:4 row_mask:0xf bank_mask:0xf bound_ctrl:1
  v_max_u32_dpp v136, v136, v136 row_shr:8 row_mask:0xf bank_mask:0xf bound_ctrl:1
  v_max_u32_dpp v137, v137, v137 row_shr:8 row_mask:0xf bank_mask:0xf bound_ctrl:1
  v_max_u32_dpp v138, v138, v138 row_shr:8 row_mask:0xf bank_mask:0xf bound_ctrl:1
  v_max_u32_dpp v139, v139, v139 row_shr:8 row_mask:0xf bank_mask:0xf bound_ctrl:1
  v_max_u32_dpp v140, v140, v140 row_shr:8 row_mask:0xf bank_mask:0xf bound_ctrl:1
  v_max_u32_dpp v141, v141, v141 row_shr:8 row_mask:0xf bank_mask:0xf bound_ctrl:1
  v_max_u32_dpp v136, v136, v136 row_bcast:15 row_mask:0xa bank_mask:0xf
  v_max_u32_dpp v137, v137, v137 row_bcast:15 row_mask:0xa bank_mask:0xf
  v_max_u32_dpp v138, v138, v138 row_bcast:15 row_mask:0xa bank_mask:0xf
  v_max_u32_dpp v139, v139, v139 row_bcast:15 row_mask:0xa bank_mask:0xf
  v_max_u32_dpp v140, v140, v140 row_bcast:15 row_mask:0xa bank_mask:0xf
  v_max_u32_dpp v141, v141, v141 row_bcast:15 row_mask:0xa bank_mask:0xf
  v_max_u32_dpp v136, v136, v136 row_bcast:31 row_mask:0xc bank_mask:0xf
  v_max_u32_dpp v137, v137, v137 row_bcast:31 row_mask:0xc bank_mask:0xf
  v_max_u32_dpp v138, v138, v138 row_bcast:31 row_mask:0xc bank_mask:0xf
  v_max_u32_dpp v139, v139, v139 row_bcast:31 row_mask:0xc bank_mask:0xf
  v_max_u32_dpp v140, v140, v140 row_bcast:31 row_mask:0xc bank_mask:0xf
  v_max_u32_dpp v141, v141, v141 row_bcast:31 row_mask:0xc bank_mask:0xf
  s_cmp_le_u32 s51, 0
  s_cbranch_scc1 k2_loaded
  v_max_u32 v136, s50, v136
  s_nop 0
  v_readlane_b32 s50, v136, 63
  v_and_b32 v198, 0xfffff, v136
  v_add_u32 v199, 0, v196
  v_cmp_gt_u32 s[56:57], s22, v199
  v_add_u32 v198, v198, v199
  v_add_u32 v198, s21, v198
  s_mov_b64 exec, s[56:57]
  s_cbranch_execz k2_ld0
  v_lshlrev_b32 v199, 4, v198
  buffer_load_dwordx4 v[88:91], v199, s[8:11], s52 offen
  buffer_load_ubyte v152, v198, s[8:11], s53 offen
k2_ld0:
  s_mov_b64 exec, -1
  s_cmp_le_u32 s51, 1
  s_cbranch_scc1 k2_loaded
  v_max_u32 v137, s50, v137
  s_nop 0
  v_readlane_b32 s50, v137, 63
  v_and_b32 v198, 0xfffff, v137
  v_add_u32 v199, 64, v196
  v_cmp_gt_u32 s[58:59], s22, v199
  v_add_u32 v198, v198, v199
  v_add_u32 v198, s21, v198
  s_mov_b64 exec, s[58:59]
  s_cbranch_execz k2_ld1
  v_lshlrev_b32 v199, 4, v198
  buffer_load_dwordx4 v[92:95], v199, s[8:11], s52 offen
  buffer_load_ubyte v153, v198, s[8:11], s53 offen
k2_ld1:
  s_mov_b64 exec, -1
  s_cmp_le_u32 s51, 2
  s_cbranch_scc1 k2_loaded
  v_max_u32 v138, s50, v138
  s_nop 0
  v_readlane_b32 s50, v138, 63
  v_and_b32 v198, 0xfffff, v138
  v_add_u32 v199, 128, v196
  v_cmp_gt_u32 s[60:61], s22, v199
  v_add_u32 v198, v198, v199
  v_add_u32 v198, s21, v198
  s_mov_b64 exec, s[60:61]
  s_cbranch_execz k2_ld2
  v_lshlrev_b32 v199, 4, v198
  buffer_load_dwordx4 v[96:99], v199, s[8:11], s52 offen
  buffer_load_ubyte v154, v198, s[8:11], s53 offen
k2_ld2:
  s_mov_b64 exec, -1
  s_cmp_le_u32 s51, 3
  s_cbranch_scc1 k2_loaded
  v_max_u32 v139, s50, v139
  s_nop 0
  v_readlane_b32 s50, v139, 63
  v_and_b32 v198, 0xfffff, v139
  v_add_u32 v199, 192, v196
  v_cmp_gt_u32 s[62:63], s22, v199
  v_add_u32 v198, v198, v199
  v_add_u32 v198, s21, v198
  s_mov_b64 exec, s[62:63]
  s_cbranch_execz k2_ld3
  v_lshlrev_b32 v199, 4, v198
  buffer_load_dwordx4 v[100:103], v199, s[8:11], s52 offen
  buffer_load_ubyte v155, v198, s[8:11], s53 offen
k2_ld3:
  s_mov_b64 exec, -1
  s_cmp_le_u32 s51, 4
  s_cbranch_scc1 k2_loaded
  v_max_u32 v140, s50, v140
  s_nop 0
  v_readlane_b32 s50, v140, 63
  v_and_b32 v198, 0xfffff, v140
  v_add_u32 v199, 256, v196
  v_cmp_gt_u32 s[64:65], s22, v199
  v_add_u32 v198, v198, v199
  v_add_u32 v198, s21, v198
  s_mov_b64 exec, s[64:65]
  s_cbranch_execz k2_ld4
  v_lshlrev_b32 v199, 4, v198
  buffer_load_dwordx4 v[104:107], v199, s[8:11], s52 offen
  buffer_load_ubyte v156, v198, s[8:11], s53 offen
k2_ld4:
  s_mov_b64 exec, -1
  s_cmp_le_u32 s51, 5
  s_cbranch_scc1 k2_loaded
  v_max_u32 v141, s50, v141
  s_nop 0
  v_readlane_b32 s50, v141, 63
  v_and_b32 v198, 0xfffff, v141
  v_add_u32 v199, 320, v196
  v_cmp_gt_u32 s[66:67], s22, v199
  v_add_u32 v198, v198, v199
  v_add_u32 v198, s21, v198
  s_mov_b64 exec, s[66:67]
  s_cbranch_execz k2_ld5
  v_lshlrev_b32 v199, 4, v198
  buffer_load_dwordx4 v[108:111], v199, s[8:11], s52 offen
  buffer_load_ubyte v157, v198, s[8:11], s53 offen
k2_ld5:
  s_mov_b64 exec, -1
k2_loaded:
  s_mov_b32 s21, s21
  s_waitcnt vmcnt(0)
  s_branch k2_rank
k2_end:
  s_endpgm
.section .rodata,"a"
.p2align 6
.amdhsa_kernel gather_scatter__tensor_product_equiv_equiformer__graph_kernel
  .amdhsa_next_free_vgpr 256
  .amdhsa_next_free_sgpr 96
  .amdhsa_accum_offset 256
  .amdhsa_group_segment_fixed_size 0
  .amdhsa_kernarg_size 96
  .amdhsa_user_sgpr_count 2
  .amdhsa_user_sgpr_kernarg_segment_ptr 1
  .amdhsa_system_sgpr_workgroup_id_x 1
.end_amdhsa_kernel
.text
```
